```python
import torch

def _softmax(x, axis=-1):
    return torch.softmax(x, dim=axis)
def _gelu(x):
    return torch.nn.functional.gelu(x, approximate="tanh")
def _silu(x):
    return torch.nn.functional.silu(x)
def _sigmoid(x):
    return torch.sigmoid(x)
def _layernorm(x, axis=-1, eps=1e-5):
    m = x.mean(dim=axis, keepdim=True)
    v = x.var(dim=axis, keepdim=True, unbiased=False)
    return (x - m) / torch.sqrt(v + eps)
def _scatter_add(tgt, idx, src, axis=0):
    return tgt.clone().index_add_(axis, idx, src)
def _segment_sum(src, seg, n):
    out = torch.zeros((n,) + src.shape[1:], dtype=src.dtype)
    return out.index_add_(0, seg, src)
def _pad(x, pw):
    flat = tuple(v for pair in reversed(pw) for v in pair)
    return torch.nn.functional.pad(x, flat)

kernel_name = 'interleave_layers__linear_kernel_hedgehog__geglu_ffn__prompt'

def setup_inputs():

    _w = (lambda a: (lambda t: t.to(torch.bfloat16) if t.is_floating_point() else t)(torch.as_tensor(a)))
    def _A_setup():
        B, S, D, H = 1, 2048, 640, 32
        Dh = D // H
        return {
            "x": _w((lambda *s: torch.randn(*s, dtype=torch.bfloat16) * 0.05)(B, S, D)),
            "wqkv": _w((lambda *s: torch.randn(*s, dtype=torch.bfloat16) * 0.2)(D, 3 * D)),
            "w_phi": _w((lambda *s: torch.randn(*s, dtype=torch.bfloat16) * 0.2)(H, Dh, Dh) * (Dh ** -0.5)),
            "wo": _w((lambda *s: torch.randn(*s, dtype=torch.bfloat16) * 0.05)(D, D)),
        }
    _A_in = _A_setup()

    def _B_setup():
        B, S, D, F = 1, 2048, 640, 1536
        return {
            "x": _w((lambda *s: torch.randn(*s, dtype=torch.bfloat16) * 0.05)(B, S, D)),
            "w_gate": _w((lambda *s: torch.randn(*s, dtype=torch.bfloat16) * 0.05)(D, F)),
            "w_up": _w((lambda *s: torch.randn(*s, dtype=torch.bfloat16) * 0.05)(D, F)),
            "w_down": _w((lambda *s: torch.randn(*s, dtype=torch.bfloat16) * 0.05)(F, D)),
        }
    _B_in = _B_setup()

    return {
        "A_x": _A_in["x"],
        "A_wqkv": _A_in["wqkv"],
        "A_w_phi": _A_in["w_phi"],
        "A_wo": _A_in["wo"],
        "B_x": _B_in["x"],
        "B_w_gate": _B_in["w_gate"],
        "B_w_up": _B_in["w_up"],
        "B_w_down": _B_in["w_down"],
    }

def reference(A_x, A_wqkv, A_w_phi, A_wo, B_x, B_w_gate, B_w_up, B_w_down):
    def _A_ref(x, wqkv, w_phi, wo):
        B, S, D = x.shape
        H = 32; Dh = D // H
        qkv = (lambda x, *d: x.permute(*d))((x @ wqkv).reshape(B, S, 3, H, Dh), 2, 0, 3, 1, 4)
        q, k, v = qkv[0], qkv[1], qkv[2]
        pq = torch.einsum("bhsd,hdf->bhsf", q, w_phi)
        pk = torch.einsum("bhsd,hdf->bhsf", k, w_phi)
        phi_q = torch.concatenate([_softmax(pq, axis=-1), _softmax(-pq, axis=-1)], axis=-1)
        phi_k = torch.concatenate([_softmax(pk, axis=-1), _softmax(-pk, axis=-1)], axis=-1)
        kv = torch.einsum("bhsf,bhsd->bhfd", phi_k, v)
        z  = torch.einsum("bhsf->bhf", phi_k)
        num = torch.einsum("bhqf,bhfd->bhqd", phi_q, kv)
        den = torch.einsum("bhqf,bhf->bhq", phi_q, z)[..., None] + 1e-6
        o = num / den
        return (lambda x, *d: x.permute(*d))(o, 0, 2, 1, 3).reshape(B, S, D) @ wo

    def _B_ref(x, w_gate, w_up, w_down):
        return (_gelu(x @ w_gate) * (x @ w_up)) @ w_down

    x = A_x
    x = x + _A_ref(_layernorm(x, axis=-1), A_wqkv, A_w_phi, A_wo)
    x = x + _B_ref(_layernorm(x, axis=-1), B_w_gate, B_w_up, B_w_down)
    x = x + _A_ref(_layernorm(x, axis=-1), A_wqkv, A_w_phi, A_wo)
    x = x + _B_ref(_layernorm(x, axis=-1), B_w_gate, B_w_up, B_w_down)
    return x
```

```asm
; @launch kernel=prep_kernel grid=(513,1,1) block=(256,1,1) lds=28672
; @launch kernel=hedgehog_main_kernel grid=(256,1,1) block=(256,1,1) lds=163840
.amdgcn_target "amdgcn-amd-amdhsa--gfx950"
.text
.globl prep_kernel
.p2align 8
.type prep_kernel,@function
prep_kernel:
  s_cmp_ge_u32 s2, 513
  s_cbranch_scc1 P0_END
  s_load_dwordx8 s[40:47], s[0:1], 0
  s_load_dwordx4 s[48:51], s[0:1], 40
  s_load_dwordx2 s[52:53], s[0:1], 56
  s_load_dwordx2 s[54:55], s[0:1], 80
  v_lshrrev_b32 v1, 6, v0
  v_and_b32 v2, 63, v0
  v_readfirstlane_b32 s16, v1
  v_mov_b32 v3, 0x3f803f80
  v_lshlrev_b32 v4, 4, v2
  s_cmp_lt_u32 s2, 96
  s_cbranch_scc1 P0_WA
  s_cmp_lt_u32 s2, 288
  s_cbranch_scc1 P0_WC
  s_cmp_lt_u32 s2, 416
  s_cbranch_scc1 P0_WD
  s_cmp_lt_u32 s2, 448
  s_cbranch_scc1 P0_WB
  s_cmp_lt_u32 s2, 512
  s_cbranch_scc1 P0_X
  s_waitcnt lgkmcnt(0)
  s_mov_b32 s4, s54
  s_mov_b32 s5, s55
  s_mov_b32 s6, 0x10000000
  s_mov_b32 s7, 0x20000
  v_lshlrev_b32 v5, 4, v0
  v_mov_b32 v8, 0
  v_mov_b32 v9, 0
  v_mov_b32 v10, 0
  v_mov_b32 v11, 0
  s_mov_b32 s20, 0x0
  buffer_store_dwordx4 v[8:11], v5, s[4:7], s20 offen
  s_mov_b32 s20, 0x1000
  buffer_store_dwordx4 v[8:11], v5, s[4:7], s20 offen
  s_mov_b32 s20, 0x2000
  buffer_store_dwordx4 v[8:11], v5, s[4:7], s20 offen
  s_mov_b32 s20, 0x3000
  buffer_store_dwordx4 v[8:11], v5, s[4:7], s20 offen
  s_mov_b32 s20, 0x4000
  buffer_store_dwordx4 v[8:11], v5, s[4:7], s20 offen
  s_mov_b32 s20, 0x5000
  buffer_store_dwordx4 v[8:11], v5, s[4:7], s20 offen
  s_mov_b32 s20, 0x6000
  buffer_store_dwordx4 v[8:11], v5, s[4:7], s20 offen
  s_mov_b32 s20, 0x7000
  buffer_store_dwordx4 v[8:11], v5, s[4:7], s20 offen
  s_endpgm
P0_WA:
  s_waitcnt lgkmcnt(0)
  s_mov_b32 s4, s54
  s_mov_b32 s5, s55
  s_mov_b32 s6, 0x10000000
  s_mov_b32 s7, 0x20000
  s_mov_b32 s8, s42
  s_mov_b32 s9, s43
  s_mov_b32 s10, 0x258000
  s_mov_b32 s11, 0x20000
  s_mov_b32 s12, s44
  s_mov_b32 s13, s45
  s_mov_b32 s14, 0x6400
  s_mov_b32 s15, 0x20000
  s_and_b32 s20, s2, 7
  s_lshr_b32 s21, s2, 3
  s_cmp_ge_u32 s21, 6
  s_cselect_b32 s22, 1, 0
  s_cselect_b32 s23, 6, 0
  s_sub_u32 s21, s21, s23
  s_lshl_b32 s20, s20, 1
  s_add_u32 s20, s20, s22
  s_mul_i32 s20, s20, 6
  s_add_u32 s20, s20, s21
  s_lshl_b32 s20, s20, 2
  s_add_u32 s20, s20, s16
  s_mul_i32 s21, s20, 2731
  s_lshr_b32 s21, s21, 16
  s_mul_i32 s22, s21, 24
  s_sub_u32 s22, s20, s22
  s_mul_i32 s23, s22, 43
  s_lshr_b32 s23, s23, 8
  s_mul_i32 s24, s23, 6
  s_sub_u32 s24, s22, s24
  s_lshr_b32 s25, s24, 1
  s_and_b32 s26, s24, 1
  s_lshl_b32 s27, s21, 1
  s_add_u32 s27, s27, s26
  s_add_u32 s28, s25, 1
  s_mul_i32 s28, s28, 640
  s_cmp_eq_u32 s25, 2
  s_cselect_b32 s28, 0, s28
  s_mul_i32 s29, s27, 20
  s_add_u32 s28, s28, s29
  s_lshl_b32 s28, s28, 1
  s_mul_i32 s29, s23, 614400
  s_add_u32 s28, s28, s29
  v_and_b32 v5, 31, v2
  v_lshrrev_b32 v6, 5, v2
  v_and_b32 v7, 0x13, v5
  v_bfe_u32 v8, v5, 2, 1
  v_lshl_add_u32 v7, v8, 3, v7
  v_bfe_u32 v8, v5, 3, 1
  v_lshl_add_u32 v7, v8, 2, v7
  v_mul_u32_u24 v7, 3840, v7
  v_lshl_add_u32 v7, v6, 4, v7
  s_add_u32 s30, s28, 0
  buffer_load_dwordx4 v[32:35], v7, s[8:11], s30 offen offset:0
  buffer_load_dwordx4 v[36:39], v7, s[8:11], s30 offen offset:32
  s_add_u32 s30, s28, 122880
  buffer_load_dwordx4 v[40:43], v7, s[8:11], s30 offen offset:0
  buffer_load_dwordx4 v[44:47], v7, s[8:11], s30 offen offset:32
  s_add_u32 s30, s28, 245760
  buffer_load_dwordx4 v[48:51], v7, s[8:11], s30 offen offset:0
  buffer_load_dwordx4 v[52:55], v7, s[8:11], s30 offen offset:32
  s_add_u32 s30, s28, 368640
  buffer_load_dwordx4 v[56:59], v7, s[8:11], s30 offen offset:0
  buffer_load_dwordx4 v[60:63], v7, s[8:11], s30 offen offset:32
  s_add_u32 s30, s28, 491520
  buffer_load_dwordx4 v[64:67], v7, s[8:11], s30 offen offset:0
  buffer_load_dwordx4 v[68:71], v7, s[8:11], s30 offen offset:32
  s_cmp_eq_u32 s25, 1
  s_cbranch_scc1 P0_WA_ID
  v_lshlrev_b32 v8, 1, v5
  v_mul_u32_u24 v9, 320, v6
  v_add_u32 v8, v8, v9
  s_mul_i32 s30, s27, 800
  v_mov_b32 v10, 0x40000000
  v_cmp_gt_u32 vcc, 20, v5
  s_nop 1
  v_cndmask_b32 v8, v10, v8, vcc
  v_cmp_eq_u32 vcc, 0, v6
  s_nop 1
  v_cndmask_b32 v9, v10, v8, vcc
  buffer_load_ushort v80, v8, s[12:15], s30 offen offset:0
  buffer_load_ushort v81, v8, s[12:15], s30 offen offset:40
  buffer_load_ushort v82, v8, s[12:15], s30 offen offset:80
  buffer_load_ushort v83, v8, s[12:15], s30 offen offset:120
  buffer_load_ushort v84, v8, s[12:15], s30 offen offset:160
  buffer_load_ushort v85, v8, s[12:15], s30 offen offset:200
  buffer_load_ushort v86, v8, s[12:15], s30 offen offset:240
  buffer_load_ushort v87, v8, s[12:15], s30 offen offset:280
  buffer_load_ushort v88, v9, s[12:15], s30 offen offset:640
  buffer_load_ushort v89, v9, s[12:15], s30 offen offset:680
  buffer_load_ushort v90, v9, s[12:15], s30 offen offset:720
  buffer_load_ushort v91, v9, s[12:15], s30 offen offset:760
  s_waitcnt vmcnt(10)
  v_lshl_or_b32 v72, v81, 16, v80
  s_waitcnt vmcnt(8)
  v_lshl_or_b32 v73, v83, 16, v82
  s_waitcnt vmcnt(6)
  v_lshl_or_b32 v74, v85, 16, v84
  s_waitcnt vmcnt(4)
  v_lshl_or_b32 v75, v87, 16, v86
  s_waitcnt vmcnt(2)
  v_lshl_or_b32 v76, v89, 16, v88
  s_waitcnt vmcnt(0)
  v_lshl_or_b32 v77, v91, 16, v90
  v_mov_b32 v78, 0
  v_mov_b32 v79, 0
  s_waitcnt vmcnt(0) lgkmcnt(0)
  s_branch P0_WA_GO
P0_WA_ID:
  v_lshlrev_b32 v8, 3, v6
  v_sub_u32 v8, v5, v8
  v_mov_b32 v10, 0x3f80
  v_mov_b32 v11, 0x3f800000
  v_mov_b32 v12, 0
  v_cmp_eq_u32 vcc, 0, v8
  s_nop 1
  v_cndmask_b32 v72, v12, v10, vcc
  v_cmp_eq_u32 vcc, 1, v8
  s_nop 1
  v_cndmask_b32 v72, v72, v11, vcc
  v_cmp_eq_u32 vcc, 2, v8
  s_nop 1
  v_cndmask_b32 v73, v12, v10, vcc
  v_cmp_eq_u32 vcc, 3, v8
  s_nop 1
  v_cndmask_b32 v73, v73, v11, vcc
  v_cmp_eq_u32 vcc, 4, v8
  s_nop 1
  v_cndmask_b32 v74, v12, v10, vcc
  v_cmp_eq_u32 vcc, 5, v8
  s_nop 1
  v_cndmask_b32 v74, v74, v11, vcc
  v_cmp_eq_u32 vcc, 6, v8
  s_nop 1
  v_cndmask_b32 v75, v12, v10, vcc
  v_cmp_eq_u32 vcc, 7, v8
  s_nop 1
  v_cndmask_b32 v75, v75, v11, vcc
  v_subrev_u32 v8, 16, v8
  v_cmp_eq_u32 vcc, 0, v8
  s_nop 1
  v_cndmask_b32 v76, v12, v10, vcc
  v_cmp_eq_u32 vcc, 1, v8
  s_nop 1
  v_cndmask_b32 v76, v76, v11, vcc
  v_cmp_eq_u32 vcc, 2, v8
  s_nop 1
  v_cndmask_b32 v77, v12, v10, vcc
  v_cmp_eq_u32 vcc, 3, v8
  s_nop 1
  v_cndmask_b32 v77, v77, v11, vcc
  v_cmp_eq_u32 vcc, 4, v8
  s_nop 1
  v_cndmask_b32 v78, v12, v10, vcc
  v_cmp_eq_u32 vcc, 5, v8
  s_nop 1
  v_cndmask_b32 v78, v78, v11, vcc
  v_cmp_eq_u32 vcc, 6, v8
  s_nop 1
  v_cndmask_b32 v79, v12, v10, vcc
  v_cmp_eq_u32 vcc, 7, v8
  s_nop 1
  v_cndmask_b32 v79, v79, v11, vcc
  s_waitcnt vmcnt(0) lgkmcnt(0)
P0_WA_GO:
  s_mul_i32 s30, s25, 20
  v_add_u32 v8, s30, v5
  v_lshrrev_b32 v9, 4, v8
  v_and_b32 v10, 15, v8
  v_lshrrev_b32 v11, 2, v10
  v_lshlrev_b32 v11, 3, v11
  v_and_b32 v10, 3, v10
  v_add_u32 v11, v11, v10
  s_lshl_b32 s31, s26, 2
  v_add_u32 v11, s31, v11
  v_lshl_add_u32 v12, v6, 5, v11
  v_lshlrev_b32 v12, 4, v12
  v_cmp_gt_u32 vcc, 3, v9
  v_mov_b32 v13, 120
  s_nop 0
  v_cndmask_b32 v13, v13, v9, vcc
  v_mov_b32 v14, 1024
  v_mov_b32 v15, 3072
  v_cndmask_b32 v14, v14, v15, vcc
  v_lshl_add_u32 v12, v13, 10, v12
  s_mul_i32 s31, s23, 10
  v_mul_lo_u32 v15, v14, s31
  v_add_u32 v12, v12, v15
  s_cmp_eq_u32 s25, 2
  s_cselect_b32 s32, 24, 20
  v_cmp_gt_u32 vcc, s32, v5
  v_mov_b32 v16, 0x40000000
  s_nop 0
  v_cndmask_b32 v12, v16, v12, vcc
  v_lshlrev_b32 v17, 10, v9
  v_lshl_add_u32 v17, v11, 4, v17
  v_cndmask_b32 v17, v16, v17, vcc
  v_cmp_eq_u32 vcc, 0, v6
  s_nop 1
  v_cndmask_b32 v17, v16, v17, vcc
  s_mul_i32 s33, s21, 163840
  s_add_u32 s33, s33, 0x10000
  v_mov_b32 v18, 0
  v_mfma_f32_32x32x16_bf16 v[96:111], v[32:35], v[72:75], 0
  v_mfma_f32_32x32x16_bf16 v[96:111], v[36:39], v[76:79], v[96:111]
  s_nop 11
  v_cvt_pk_bf16_f32 v112, v96, v97
  v_cvt_pk_bf16_f32 v113, v98, v99
  v_cvt_pk_bf16_f32 v114, v100, v101
  v_cvt_pk_bf16_f32 v115, v102, v103
  v_cvt_pk_bf16_f32 v116, v104, v105
  v_cvt_pk_bf16_f32 v117, v106, v107
  v_cvt_pk_bf16_f32 v118, v108, v109
  v_cvt_pk_bf16_f32 v119, v110, v111
  v_dot2c_f32_bf16 v18, v112, v3
  v_dot2c_f32_bf16 v18, v113, v3
  v_dot2c_f32_bf16 v18, v114, v3
  v_dot2c_f32_bf16 v18, v115, v3
  v_dot2c_f32_bf16 v18, v116, v3
  v_dot2c_f32_bf16 v18, v117, v3
  v_dot2c_f32_bf16 v18, v118, v3
  v_dot2c_f32_bf16 v18, v119, v3
  buffer_store_dwordx4 v[112:115], v12, s[4:7], s33 offen
  v_add_u32 v19, v12, v14
  buffer_store_dwordx4 v[116:119], v19, s[4:7], s33 offen
  v_add_u32 v12, v19, v14
  v_mfma_f32_32x32x16_bf16 v[96:111], v[40:43], v[72:75], 0
  v_mfma_f32_32x32x16_bf16 v[96:111], v[44:47], v[76:79], v[96:111]
  s_nop 11
  v_cvt_pk_bf16_f32 v112, v96, v97
  v_cvt_pk_bf16_f32 v113, v98, v99
  v_cvt_pk_bf16_f32 v114, v100, v101
  v_cvt_pk_bf16_f32 v115, v102, v103
  v_cvt_pk_bf16_f32 v116, v104, v105
  v_cvt_pk_bf16_f32 v117, v106, v107
  v_cvt_pk_bf16_f32 v118, v108, v109
  v_cvt_pk_bf16_f32 v119, v110, v111
  v_dot2c_f32_bf16 v18, v112, v3
  v_dot2c_f32_bf16 v18, v113, v3
  v_dot2c_f32_bf16 v18, v114, v3
  v_dot2c_f32_bf16 v18, v115, v3
  v_dot2c_f32_bf16 v18, v116, v3
  v_dot2c_f32_bf16 v18, v117, v3
  v_dot2c_f32_bf16 v18, v118, v3
  v_dot2c_f32_bf16 v18, v119, v3
  buffer_store_dwordx4 v[112:115], v12, s[4:7], s33 offen
  v_add_u32 v19, v12, v14
  buffer_store_dwordx4 v[116:119], v19, s[4:7], s33 offen
  v_add_u32 v12, v19, v14
  v_mfma_f32_32x32x16_bf16 v[96:111], v[48:51], v[72:75], 0
  v_mfma_f32_32x32x16_bf16 v[96:111], v[52:55], v[76:79], v[96:111]
  s_nop 11
  v_cvt_pk_bf16_f32 v112, v96, v97
  v_cvt_pk_bf16_f32 v113, v98, v99
  v_cvt_pk_bf16_f32 v114, v100, v101
  v_cvt_pk_bf16_f32 v115, v102, v103
  v_cvt_pk_bf16_f32 v116, v104, v105
  v_cvt_pk_bf16_f32 v117, v106, v107
  v_cvt_pk_bf16_f32 v118, v108, v109
  v_cvt_pk_bf16_f32 v119, v110, v111
  v_dot2c_f32_bf16 v18, v112, v3
  v_dot2c_f32_bf16 v18, v113, v3
  v_dot2c_f32_bf16 v18, v114, v3
  v_dot2c_f32_bf16 v18, v115, v3
  v_dot2c_f32_bf16 v18, v116, v3
  v_dot2c_f32_bf16 v18, v117, v3
  v_dot2c_f32_bf16 v18, v118, v3
  v_dot2c_f32_bf16 v18, v119, v3
  buffer_store_dwordx4 v[112:115], v12, s[4:7], s33 offen
  v_add_u32 v19, v12, v14
  buffer_store_dwordx4 v[116:119], v19, s[4:7], s33 offen
  v_add_u32 v12, v19, v14
  v_mfma_f32_32x32x16_bf16 v[96:111], v[56:59], v[72:75], 0
  v_mfma_f32_32x32x16_bf16 v[96:111], v[60:63], v[76:79], v[96:111]
  s_nop 11
  v_cvt_pk_bf16_f32 v112, v96, v97
  v_cvt_pk_bf16_f32 v113, v98, v99
  v_cvt_pk_bf16_f32 v114, v100, v101
  v_cvt_pk_bf16_f32 v115, v102, v103
  v_cvt_pk_bf16_f32 v116, v104, v105
  v_cvt_pk_bf16_f32 v117, v106, v107
  v_cvt_pk_bf16_f32 v118, v108, v109
  v_cvt_pk_bf16_f32 v119, v110, v111
  v_dot2c_f32_bf16 v18, v112, v3
  v_dot2c_f32_bf16 v18, v113, v3
  v_dot2c_f32_bf16 v18, v114, v3
  v_dot2c_f32_bf16 v18, v115, v3
  v_dot2c_f32_bf16 v18, v116, v3
  v_dot2c_f32_bf16 v18, v117, v3
  v_dot2c_f32_bf16 v18, v118, v3
  v_dot2c_f32_bf16 v18, v119, v3
  buffer_store_dwordx4 v[112:115], v12, s[4:7], s33 offen
  v_add_u32 v19, v12, v14
  buffer_store_dwordx4 v[116:119], v19, s[4:7], s33 offen
  v_add_u32 v12, v19, v14
  v_mfma_f32_32x32x16_bf16 v[96:111], v[64:67], v[72:75], 0
  v_mfma_f32_32x32x16_bf16 v[96:111], v[68:71], v[76:79], v[96:111]
  s_nop 11
  v_cvt_pk_bf16_f32 v112, v96, v97
  v_cvt_pk_bf16_f32 v113, v98, v99
  v_cvt_pk_bf16_f32 v114, v100, v101
  v_cvt_pk_bf16_f32 v115, v102, v103
  v_cvt_pk_bf16_f32 v116, v104, v105
  v_cvt_pk_bf16_f32 v117, v106, v107
  v_cvt_pk_bf16_f32 v118, v108, v109
  v_cvt_pk_bf16_f32 v119, v110, v111
  v_dot2c_f32_bf16 v18, v112, v3
  v_dot2c_f32_bf16 v18, v113, v3
  v_dot2c_f32_bf16 v18, v114, v3
  v_dot2c_f32_bf16 v18, v115, v3
  v_dot2c_f32_bf16 v18, v116, v3
  v_dot2c_f32_bf16 v18, v117, v3
  v_dot2c_f32_bf16 v18, v118, v3
  v_dot2c_f32_bf16 v18, v119, v3
  buffer_store_dwordx4 v[112:115], v12, s[4:7], s33 offen
  v_add_u32 v19, v12, v14
  buffer_store_dwordx4 v[116:119], v19, s[4:7], s33 offen
  v_add_u32 v12, v19, v14
  v_mov_b32 v19, v18
  s_nop 1
  v_permlane32_swap_b32 v18, v19
  v_add_f32 v18, v18, v19
  s_lshl_b32 s34, s21, 12
  s_add_u32 s34, s34, 0x290000
  s_lshr_b32 s35, s23, 1
  s_lshl_b32 s35, s35, 9
  s_add_u32 s34, s34, s35
  s_and_b32 s35, s23, 1
  s_lshl_b32 s35, s35, 3
  s_add_u32 s34, s34, s35
  v_cvt_pk_bf16_f32 v20, v18, v18
  v_and_b32 v22, 0xffff0000, v20
  v_sub_f32 v22, v18, v22
  v_cvt_pk_bf16_f32 v21, v22, v22
  buffer_store_dwordx2 v[20:21], v17, s[4:7], s34 offen
  s_endpgm
P0_WC:
  s_waitcnt lgkmcnt(0)
  s_mov_b32 s4, s54
  s_mov_b32 s5, s55
  s_mov_b32 s6, 0x10000000
  s_mov_b32 s7, 0x20000
  s_sub_u32 s20, s2, 96
  s_cmp_ge_u32 s20, 96
  s_cselect_b32 s21, 1, 0
  s_cselect_b32 s8, s50, s48
  s_cselect_b32 s9, s51, s49
  s_mov_b32 s10, 0x1e0000
  s_mov_b32 s11, 0x20000
  s_mul_i32 s22, s21, 96
  s_sub_u32 s22, s20, s22
  s_lshr_b32 s23, s22, 2
  s_and_b32 s24, s22, 3
  v_lshrrev_b32 v8, 3, v2
  v_mul_u32_u24 v8, 3072, v8
  v_and_b32 v9, 7, v2
  v_lshl_add_u32 v8, v9, 4, v8
  s_mul_i32 s25, s24, 491520
  s_lshl_b32 s26, s23, 7
  s_add_u32 s25, s25, s26
  s_mul_i32 s26, s16, 122880
  s_add_u32 s25, s25, s26
  s_mul_i32 s27, s16, 5120
  s_add_u32 m0, s27, 0
  s_add_u32 s28, s25, 0
  buffer_load_dwordx4 v8, s[8:11], s28 offen lds
  s_add_u32 m0, s27, 1024
  s_add_u32 s28, s25, 24576
  buffer_load_dwordx4 v8, s[8:11], s28 offen lds
  s_add_u32 m0, s27, 2048
  s_add_u32 s28, s25, 49152
  buffer_load_dwordx4 v8, s[8:11], s28 offen lds
  s_add_u32 m0, s27, 3072
  s_add_u32 s28, s25, 73728
  buffer_load_dwordx4 v8, s[8:11], s28 offen lds
  s_add_u32 m0, s27, 4096
  s_add_u32 s28, s25, 98304
  buffer_load_dwordx4 v8, s[8:11], s28 offen lds
  v_lshrrev_b32 v5, 4, v2
  v_bfe_u32 v6, v2, 2, 2
  v_and_b32 v7, 3, v2
  v_lshl_add_u32 v9, v5, 3, v6
  v_lshlrev_b32 v9, 7, v9
  v_lshl_add_u32 v9, v7, 3, v9
  s_lshl_b32 s26, s16, 5
  v_add_u32 v9, s26, v9
  s_lshl_b32 s26, s23, 2
  s_add_u32 s26, s26, s16
  s_mul_i32 s27, s26, 171
  s_lshr_b32 s27, s27, 10
  s_mul_i32 s28, s27, 6
  s_sub_u32 s28, s26, s28
  s_lshr_b32 s28, s28, 1
  s_and_b32 s29, s26, 1
  s_lshl_b32 s30, s21, 1
  s_add_u32 s29, s29, s30
  s_mul_i32 s30, s27, 240
  s_mul_i32 s31, s28, 80
  s_add_u32 s30, s30, s31
  s_mul_i32 s31, s24, 20
  s_add_u32 s30, s30, s31
  s_add_u32 s30, s30, s29
  s_lshl_b32 s30, s30, 10
  s_add_u32 s30, s30, 0x368000
  v_mov_b32 v18, 0
  s_waitcnt vmcnt(0) lgkmcnt(0)
  s_barrier
  ds_read_b64_tr_b16 v[32:33], v9 offset:0
  ds_read_b64_tr_b16 v[34:35], v9 offset:512
  ds_read_b64_tr_b16 v[36:37], v9 offset:4096
  ds_read_b64_tr_b16 v[38:39], v9 offset:4608
  ds_read_b64_tr_b16 v[40:41], v9 offset:8192
  ds_read_b64_tr_b16 v[42:43], v9 offset:8704
  ds_read_b64_tr_b16 v[44:45], v9 offset:12288
  ds_read_b64_tr_b16 v[46:47], v9 offset:12800
  ds_read_b64_tr_b16 v[48:49], v9 offset:16384
  ds_read_b64_tr_b16 v[50:51], v9 offset:16896
  s_add_u32 s31, s30, 0
  s_waitcnt lgkmcnt(8)
  buffer_store_dwordx4 v[32:35], v4, s[4:7], s31 offen
  v_dot2c_f32_bf16 v18, v32, v3
  v_dot2c_f32_bf16 v18, v33, v3
  v_dot2c_f32_bf16 v18, v34, v3
  v_dot2c_f32_bf16 v18, v35, v3
  s_add_u32 s31, s30, 4096
  s_waitcnt lgkmcnt(6)
  buffer_store_dwordx4 v[36:39], v4, s[4:7], s31 offen
  v_dot2c_f32_bf16 v18, v36, v3
  v_dot2c_f32_bf16 v18, v37, v3
  v_dot2c_f32_bf16 v18, v38, v3
  v_dot2c_f32_bf16 v18, v39, v3
  s_add_u32 s31, s30, 8192
  s_waitcnt lgkmcnt(4)
  buffer_store_dwordx4 v[40:43], v4, s[4:7], s31 offen
  v_dot2c_f32_bf16 v18, v40, v3
  v_dot2c_f32_bf16 v18, v41, v3
  v_dot2c_f32_bf16 v18, v42, v3
  v_dot2c_f32_bf16 v18, v43, v3
  s_add_u32 s31, s30, 12288
  s_waitcnt lgkmcnt(2)
  buffer_store_dwordx4 v[44:47], v4, s[4:7], s31 offen
  v_dot2c_f32_bf16 v18, v44, v3
  v_dot2c_f32_bf16 v18, v45, v3
  v_dot2c_f32_bf16 v18, v46, v3
  v_dot2c_f32_bf16 v18, v47, v3
  s_add_u32 s31, s30, 16384
  s_waitcnt lgkmcnt(0)
  buffer_store_dwordx4 v[48:51], v4, s[4:7], s31 offen
  v_dot2c_f32_bf16 v18, v48, v3
  v_dot2c_f32_bf16 v18, v49, v3
  v_dot2c_f32_bf16 v18, v50, v3
  v_dot2c_f32_bf16 v18, v51, v3
  s_nop 2
  v_mov_b32 v19, v18
  s_nop 1
  v_permlane16_swap_b32 v18, v19
  v_add_f32 v18, v18, v19
  v_mov_b32 v19, v18
  s_nop 1
  v_permlane32_swap_b32 v18, v19
  v_add_f32 v18, v18, v19
  v_and_b32 v10, 15, v2
  v_lshlrev_b32 v10, 4, v10
  v_lshl_add_u32 v10, v5, 9, v10
  v_mov_b32 v11, 0x40000000
  v_cmp_gt_u32 vcc, 2, v5
  s_nop 1
  v_cndmask_b32 v10, v11, v10, vcc
  v_cmp_eq_u32 vcc, 0, v5
  s_nop 1
  v_cndmask_b32 v18, 0, v18, vcc
  s_mul_i32 s31, s27, 12
  s_lshl_b32 s32, s28, 2
  s_add_u32 s31, s31, s32
  s_add_u32 s31, s31, s29
  s_lshl_b32 s31, s31, 10
  s_add_u32 s31, s31, 0x728000
  s_lshr_b32 s32, s24, 1
  s_lshl_b32 s32, s32, 8
  s_add_u32 s31, s31, s32
  s_and_b32 s32, s24, 1
  s_lshl_b32 s32, s32, 3
  s_add_u32 s31, s31, s32
  v_cvt_pk_bf16_f32 v20, v18, v18
  v_and_b32 v22, 0xffff0000, v20
  v_sub_f32 v22, v18, v22
  v_cvt_pk_bf16_f32 v21, v22, v22
  buffer_store_dwordx2 v[20:21], v10, s[4:7], s31 offen
  s_endpgm
P0_WD:
  s_waitcnt lgkmcnt(0)
  s_mov_b32 s4, s54
  s_mov_b32 s5, s55
  s_mov_b32 s6, 0x10000000
  s_mov_b32 s7, 0x20000
  s_mov_b32 s8, s52
  s_mov_b32 s9, s53
  s_mov_b32 s10, 0x1e0000
  s_mov_b32 s11, 0x20000
  s_sub_u32 s20, s2, 288
  s_lshr_b32 s23, s20, 3
  s_lshr_b32 s21, s23, 1
  s_and_b32 s22, s20, 7
  s_lshl_b32 s22, s22, 1
  s_and_b32 s23, s23, 1
  s_add_u32 s22, s22, s23
  v_mul_u32_u24 v8, 205, v2
  v_lshrrev_b32 v8, 11, v8
  v_mul_u32_u24 v9, 10, v8
  v_sub_u32 v9, v2, v9
  v_min_u32 v8, 5, v8
  v_mul_u32_u24 v8, 1280, v8
  v_lshl_add_u32 v10, v9, 4, v8
  s_mul_i32 s23, s22, 122880
  s_mul_i32 s24, s21, 160
  s_add_u32 s23, s23, s24
  s_mul_i32 s24, s16, 30720
  s_add_u32 s23, s23, s24
  s_lshl_b32 s25, s16, 12
  s_add_u32 m0, s25, 0
  s_add_u32 s26, s23, 0
  buffer_load_dwordx4 v10, s[8:11], s26 offen lds
  s_add_u32 m0, s25, 1024
  s_add_u32 s26, s23, 7680
  buffer_load_dwordx4 v10, s[8:11], s26 offen lds
  s_add_u32 m0, s25, 2048
  s_add_u32 s26, s23, 15360
  buffer_load_dwordx4 v10, s[8:11], s26 offen lds
  s_add_u32 m0, s25, 3072
  s_add_u32 s26, s23, 23040
  buffer_load_dwordx4 v10, s[8:11], s26 offen lds
  v_lshrrev_b32 v5, 4, v2
  v_bfe_u32 v6, v2, 2, 2
  v_and_b32 v7, 3, v2
  s_lshl_b32 s26, s16, 5
  v_lshl_add_u32 v11, v5, 2, v6
  v_add_u32 v11, s26, v11
  v_min_u32 v11, 79, v11
  v_mul_u32_u24 v13, 171, v11
  v_lshrrev_b32 v13, 10, v13
  v_mul_u32_u24 v12, 6, v13
  v_sub_u32 v12, v11, v12
  v_mul_u32_u24 v12, 160, v12
  v_lshl_add_u32 v12, v13, 10, v12
  v_add_u32 v11, 16, v11
  v_mul_u32_u24 v13, 171, v11
  v_lshrrev_b32 v13, 10, v13
  v_mul_u32_u24 v14, 6, v13
  v_sub_u32 v14, v11, v14
  v_mul_u32_u24 v14, 160, v14
  v_lshl_add_u32 v14, v13, 10, v14
  v_lshl_add_u32 v16, v7, 4, v12
  v_lshl_add_u32 v17, v7, 4, v14
  v_lshl_add_u32 v18, v7, 3, v12
  v_lshl_add_u32 v19, v7, 3, v14
  s_lshl_b32 s27, s16, 3
  s_lshr_b32 s28, s22, 1
  s_add_u32 s27, s27, s28
  s_mul_i32 s27, s27, 10
  s_and_b32 s28, s22, 1
  s_mul_i32 s28, s28, 5
  s_add_u32 s27, s27, s28
  s_mul_i32 s28, s21, 240
  s_add_u32 s27, s27, s28
  s_lshl_b32 s27, s27, 10
  s_add_u32 s27, s27, 0x758000
  s_waitcnt vmcnt(0) lgkmcnt(0)
  s_barrier
  s_cmp_eq_u32 s16, 3
  s_cbranch_scc1 P0_END
  ds_read_b64_tr_b16 v[32:33], v16 offset:0
  ds_read_b64_tr_b16 v[34:35], v17 offset:0
  ds_read_b64_tr_b16 v[36:37], v16 offset:8
  ds_read_b64_tr_b16 v[38:39], v17 offset:8
  ds_read_b64_tr_b16 v[40:41], v16 offset:64
  ds_read_b64_tr_b16 v[42:43], v17 offset:64
  ds_read_b64_tr_b16 v[44:45], v16 offset:72
  ds_read_b64_tr_b16 v[46:47], v17 offset:72
  ds_read_b64_tr_b16 v[48:49], v18 offset:128
  ds_read_b64_tr_b16 v[50:51], v19 offset:128
  s_add_u32 s28, s27, 0
  s_waitcnt lgkmcnt(8)
  buffer_store_dwordx4 v[32:35], v4, s[4:7], s28 offen
  s_add_u32 s28, s27, 1024
  s_waitcnt lgkmcnt(6)
  buffer_store_dwordx4 v[36:39], v4, s[4:7], s28 offen
  s_add_u32 s28, s27, 2048
  s_waitcnt lgkmcnt(4)
  buffer_store_dwordx4 v[40:43], v4, s[4:7], s28 offen
  s_add_u32 s28, s27, 3072
  s_waitcnt lgkmcnt(2)
  buffer_store_dwordx4 v[44:47], v4, s[4:7], s28 offen
  s_add_u32 s28, s27, 4096
  s_waitcnt lgkmcnt(0)
  buffer_store_dwordx4 v[48:51], v4, s[4:7], s28 offen
  s_endpgm
P0_WB:
  s_waitcnt lgkmcnt(0)
  s_mov_b32 s4, s54
  s_mov_b32 s5, s55
  s_mov_b32 s6, 0x10000000
  s_mov_b32 s7, 0x20000
  s_mov_b32 s8, s46
  s_mov_b32 s9, s47
  s_mov_b32 s10, 0xc8000
  s_mov_b32 s11, 0x20000
  s_sub_u32 s20, s2, 416
  s_and_b32 s23, s20, 7
  s_lshr_b32 s22, s23, 1
  s_and_b32 s23, s23, 1
  s_lshl_b32 s23, s23, 2
  s_lshr_b32 s21, s20, 3
  s_add_u32 s21, s21, s23
  v_mul_u32_u24 v8, 205, v2
  v_lshrrev_b32 v8, 11, v8
  v_mul_u32_u24 v9, 10, v8
  v_sub_u32 v9, v2, v9
  v_min_u32 v8, 5, v8
  v_mul_u32_u24 v8, 1280, v8
  v_lshl_add_u32 v10, v9, 4, v8
  s_mul_i32 s23, s22, 204800
  s_mul_i32 s24, s21, 160
  s_add_u32 s23, s23, s24
  s_mul_i32 s24, s16, 53760
  s_add_u32 s23, s23, s24
  s_mul_i32 s25, s16, 7168
  s_add_u32 m0, s25, 0
  s_add_u32 s26, s23, 0
  buffer_load_dwordx4 v10, s[8:11], s26 offen lds
  s_add_u32 m0, s25, 1024
  s_add_u32 s26, s23, 7680
  buffer_load_dwordx4 v10, s[8:11], s26 offen lds
  s_add_u32 m0, s25, 2048
  s_add_u32 s26, s23, 15360
  buffer_load_dwordx4 v10, s[8:11], s26 offen lds
  s_add_u32 m0, s25, 3072
  s_add_u32 s26, s23, 23040
  buffer_load_dwordx4 v10, s[8:11], s26 offen lds
  s_add_u32 m0, s25, 4096
  s_add_u32 s26, s23, 30720
  buffer_load_dwordx4 v10, s[8:11], s26 offen lds
  s_add_u32 m0, s25, 5120
  s_add_u32 s26, s23, 38400
  buffer_load_dwordx4 v10, s[8:11], s26 offen lds
  s_add_u32 m0, s25, 6144
  s_add_u32 s26, s23, 46080
  buffer_load_dwordx4 v10, s[8:11], s26 offen lds
  v_lshrrev_b32 v5, 4, v2
  v_bfe_u32 v6, v2, 2, 2
  v_and_b32 v7, 3, v2
  s_mul_i32 s27, s21, 102400
  s_add_u32 s27, s27, 0x2a0000
  s_waitcnt vmcnt(0) lgkmcnt(0)
  s_barrier
  s_and_b32 s31, s16, 1
  s_lshl_b32 s31, s31, 3
  s_lshr_b32 s32, s16, 1
  s_lshl_b32 s32, s32, 6
  s_add_u32 s31, s31, s32
  v_lshlrev_b32 v22, 4, v7
  v_add_u32 v22, s31, v22
  v_lshlrev_b32 v23, 3, v7
  v_add_u32 v23, 128, v23
  v_mov_b32 v11, 0
  v_lshl_add_u32 v11, v11, 2, v5
  v_mul_u32_u24 v12, 52, v11
  v_lshrrev_b32 v12, 8, v12
  v_mul_u32_u24 v13, 5, v12
  v_sub_u32 v13, v11, v13
  v_mul_u32_u24 v12, 40, v12
  v_add_u32 v12, v12, v6
  v_lshlrev_b32 v14, 3, v13
  v_add_u32 v15, 4, v14
  v_cmp_gt_u32 vcc, 2, v13
  s_nop 1
  v_cndmask_b32 v14, v15, v14, vcc
  v_mov_b32 v15, 16
  v_cmp_eq_u32 vcc, 4, v13
  s_nop 1
  v_cndmask_b32 v14, v14, v15, vcc
  v_add_u32 v20, v12, v14
  v_mov_b32 v15, 20
  v_cndmask_b32 v15, 4, v15, vcc
  v_add_u32 v21, v20, v15
  v_mul_u32_u24 v13, 171, v20
  v_lshrrev_b32 v13, 10, v13
  v_mul_u32_u24 v12, 6, v13
  v_sub_u32 v12, v20, v12
  v_mul_u32_u24 v12, 160, v12
  v_lshl_add_u32 v12, v13, 10, v12
  v_mul_u32_u24 v13, 171, v21
  v_lshrrev_b32 v13, 10, v13
  v_mul_u32_u24 v14, 6, v13
  v_sub_u32 v14, v21, v14
  v_mul_u32_u24 v14, 160, v14
  v_lshl_add_u32 v14, v13, 10, v14
  s_mul_i32 s28, s22, 5
  s_add_u32 s28, s28, 0
  s_cmp_ge_u32 s28, 10
  s_cselect_b32 s29, 5, 0
  s_cselect_b32 s30, 10, 0
  s_sub_u32 s28, s28, s30
  s_mul_i32 s28, s28, 10
  s_add_u32 s28, s28, s29
  s_add_u32 s28, s28, s16
  s_lshl_b32 s28, s28, 10
  s_add_u32 s28, s28, s27
  v_add_u32 v16, v12, v22
  v_add_u32 v17, v14, v22
  ds_read_b64_tr_b16 v[32:33], v16
  ds_read_b64_tr_b16 v[34:35], v17
  s_waitcnt lgkmcnt(0)
  buffer_store_dwordx4 v[32:35], v4, s[4:7], s28 offen
  v_mov_b32 v11, 1
  v_lshl_add_u32 v11, v11, 2, v5
  v_mul_u32_u24 v12, 52, v11
  v_lshrrev_b32 v12, 8, v12
  v_mul_u32_u24 v13, 5, v12
  v_sub_u32 v13, v11, v13
  v_mul_u32_u24 v12, 40, v12
  v_add_u32 v12, v12, v6
  v_lshlrev_b32 v14, 3, v13
  v_add_u32 v15, 4, v14
  v_cmp_gt_u32 vcc, 2, v13
  s_nop 1
  v_cndmask_b32 v14, v15, v14, vcc
  v_mov_b32 v15, 16
  v_cmp_eq_u32 vcc, 4, v13
  s_nop 1
  v_cndmask_b32 v14, v14, v15, vcc
  v_add_u32 v20, v12, v14
  v_mov_b32 v15, 20
  v_cndmask_b32 v15, 4, v15, vcc
  v_add_u32 v21, v20, v15
  v_mul_u32_u24 v13, 171, v20
  v_lshrrev_b32 v13, 10, v13
  v_mul_u32_u24 v12, 6, v13
  v_sub_u32 v12, v20, v12
  v_mul_u32_u24 v12, 160, v12
  v_lshl_add_u32 v12, v13, 10, v12
  v_mul_u32_u24 v13, 171, v21
  v_lshrrev_b32 v13, 10, v13
  v_mul_u32_u24 v14, 6, v13
  v_sub_u32 v14, v21, v14
  v_mul_u32_u24 v14, 160, v14
  v_lshl_add_u32 v14, v13, 10, v14
  s_mul_i32 s28, s22, 5
  s_add_u32 s28, s28, 1
  s_cmp_ge_u32 s28, 10
  s_cselect_b32 s29, 5, 0
  s_cselect_b32 s30, 10, 0
  s_sub_u32 s28, s28, s30
  s_mul_i32 s28, s28, 10
  s_add_u32 s28, s28, s29
  s_add_u32 s28, s28, s16
  s_lshl_b32 s28, s28, 10
  s_add_u32 s28, s28, s27
  v_add_u32 v16, v12, v22
  v_add_u32 v17, v14, v22
  ds_read_b64_tr_b16 v[32:33], v16
  ds_read_b64_tr_b16 v[34:35], v17
  s_waitcnt lgkmcnt(0)
  buffer_store_dwordx4 v[32:35], v4, s[4:7], s28 offen
  v_mov_b32 v11, 2
  v_lshl_add_u32 v11, v11, 2, v5
  v_mul_u32_u24 v12, 52, v11
  v_lshrrev_b32 v12, 8, v12
  v_mul_u32_u24 v13, 5, v12
  v_sub_u32 v13, v11, v13
  v_mul_u32_u24 v12, 40, v12
  v_add_u32 v12, v12, v6
  v_lshlrev_b32 v14, 3, v13
  v_add_u32 v15, 4, v14
  v_cmp_gt_u32 vcc, 2, v13
  s_nop 1
  v_cndmask_b32 v14, v15, v14, vcc
  v_mov_b32 v15, 16
  v_cmp_eq_u32 vcc, 4, v13
  s_nop 1
  v_cndmask_b32 v14, v14, v15, vcc
  v_add_u32 v20, v12, v14
  v_mov_b32 v15, 20
  v_cndmask_b32 v15, 4, v15, vcc
  v_add_u32 v21, v20, v15
  v_mul_u32_u24 v13, 171, v20
  v_lshrrev_b32 v13, 10, v13
  v_mul_u32_u24 v12, 6, v13
  v_sub_u32 v12, v20, v12
  v_mul_u32_u24 v12, 160, v12
  v_lshl_add_u32 v12, v13, 10, v12
  v_mul_u32_u24 v13, 171, v21
  v_lshrrev_b32 v13, 10, v13
  v_mul_u32_u24 v14, 6, v13
  v_sub_u32 v14, v21, v14
  v_mul_u32_u24 v14, 160, v14
  v_lshl_add_u32 v14, v13, 10, v14
  s_mul_i32 s28, s22, 5
  s_add_u32 s28, s28, 2
  s_cmp_ge_u32 s28, 10
  s_cselect_b32 s29, 5, 0
  s_cselect_b32 s30, 10, 0
  s_sub_u32 s28, s28, s30
  s_mul_i32 s28, s28, 10
  s_add_u32 s28, s28, s29
  s_add_u32 s28, s28, s16
  s_lshl_b32 s28, s28, 10
  s_add_u32 s28, s28, s27
  v_add_u32 v16, v12, v22
  v_add_u32 v17, v14, v22
  ds_read_b64_tr_b16 v[32:33], v16
  ds_read_b64_tr_b16 v[34:35], v17
  s_waitcnt lgkmcnt(0)
  buffer_store_dwordx4 v[32:35], v4, s[4:7], s28 offen
  v_mov_b32 v11, 3
  v_lshl_add_u32 v11, v11, 2, v5
  v_mul_u32_u24 v12, 52, v11
  v_lshrrev_b32 v12, 8, v12
  v_mul_u32_u24 v13, 5, v12
  v_sub_u32 v13, v11, v13
  v_mul_u32_u24 v12, 40, v12
  v_add_u32 v12, v12, v6
  v_lshlrev_b32 v14, 3, v13
  v_add_u32 v15, 4, v14
  v_cmp_gt_u32 vcc, 2, v13
  s_nop 1
  v_cndmask_b32 v14, v15, v14, vcc
  v_mov_b32 v15, 16
  v_cmp_eq_u32 vcc, 4, v13
  s_nop 1
  v_cndmask_b32 v14, v14, v15, vcc
  v_add_u32 v20, v12, v14
  v_mov_b32 v15, 20
  v_cndmask_b32 v15, 4, v15, vcc
  v_add_u32 v21, v20, v15
  v_mul_u32_u24 v13, 171, v20
  v_lshrrev_b32 v13, 10, v13
  v_mul_u32_u24 v12, 6, v13
  v_sub_u32 v12, v20, v12
  v_mul_u32_u24 v12, 160, v12
  v_lshl_add_u32 v12, v13, 10, v12
  v_mul_u32_u24 v13, 171, v21
  v_lshrrev_b32 v13, 10, v13
  v_mul_u32_u24 v14, 6, v13
  v_sub_u32 v14, v21, v14
  v_mul_u32_u24 v14, 160, v14
  v_lshl_add_u32 v14, v13, 10, v14
  s_mul_i32 s28, s22, 5
  s_add_u32 s28, s28, 3
  s_cmp_ge_u32 s28, 10
  s_cselect_b32 s29, 5, 0
  s_cselect_b32 s30, 10, 0
  s_sub_u32 s28, s28, s30
  s_mul_i32 s28, s28, 10
  s_add_u32 s28, s28, s29
  s_add_u32 s28, s28, s16
  s_lshl_b32 s28, s28, 10
  s_add_u32 s28, s28, s27
  v_add_u32 v16, v12, v22
  v_add_u32 v17, v14, v22
  ds_read_b64_tr_b16 v[32:33], v16
  ds_read_b64_tr_b16 v[34:35], v17
  s_waitcnt lgkmcnt(0)
  buffer_store_dwordx4 v[32:35], v4, s[4:7], s28 offen
  v_mov_b32 v11, 4
  v_lshl_add_u32 v11, v11, 2, v5
  v_mul_u32_u24 v12, 52, v11
  v_lshrrev_b32 v12, 8, v12
  v_mul_u32_u24 v13, 5, v12
  v_sub_u32 v13, v11, v13
  v_mul_u32_u24 v12, 40, v12
  v_add_u32 v12, v12, v6
  v_lshlrev_b32 v14, 3, v13
  v_add_u32 v15, 4, v14
  v_cmp_gt_u32 vcc, 2, v13
  s_nop 1
  v_cndmask_b32 v14, v15, v14, vcc
  v_mov_b32 v15, 16
  v_cmp_eq_u32 vcc, 4, v13
  s_nop 1
  v_cndmask_b32 v14, v14, v15, vcc
  v_add_u32 v20, v12, v14
  v_mov_b32 v15, 20
  v_cndmask_b32 v15, 4, v15, vcc
  v_add_u32 v21, v20, v15
  v_mul_u32_u24 v13, 171, v20
  v_lshrrev_b32 v13, 10, v13
  v_mul_u32_u24 v12, 6, v13
  v_sub_u32 v12, v20, v12
  v_mul_u32_u24 v12, 160, v12
  v_lshl_add_u32 v12, v13, 10, v12
  v_mul_u32_u24 v13, 171, v21
  v_lshrrev_b32 v13, 10, v13
  v_mul_u32_u24 v14, 6, v13
  v_sub_u32 v14, v21, v14
  v_mul_u32_u24 v14, 160, v14
  v_lshl_add_u32 v14, v13, 10, v14
  s_mul_i32 s28, s22, 5
  s_add_u32 s28, s28, 4
  s_cmp_ge_u32 s28, 10
  s_cselect_b32 s29, 5, 0
  s_cselect_b32 s30, 10, 0
  s_sub_u32 s28, s28, s30
  s_mul_i32 s28, s28, 10
  s_add_u32 s28, s28, s29
  s_add_u32 s28, s28, s16
  s_lshl_b32 s28, s28, 10
  s_add_u32 s28, s28, s27
  v_add_u32 v16, v12, v22
  v_add_u32 v17, v14, v22
  ds_read_b64_tr_b16 v[32:33], v16
  ds_read_b64_tr_b16 v[34:35], v17
  s_waitcnt lgkmcnt(0)
  buffer_store_dwordx4 v[32:35], v4, s[4:7], s28 offen
  s_mul_i32 s28, s22, 5
  s_add_u32 s28, s28, 4
  s_cmp_ge_u32 s28, 10
  s_cselect_b32 s29, 5, 0
  s_cselect_b32 s30, 10, 0
  s_sub_u32 s28, s28, s30
  s_mul_i32 s28, s28, 10
  s_add_u32 s28, s28, s29
  s_add_u32 s28, s28, 4
  s_lshl_b32 s28, s28, 10
  s_add_u32 s28, s28, s27
  v_add_u32 v16, v12, v23
  v_add_u32 v17, v14, v23
  ds_read_b64_tr_b16 v[32:33], v16
  ds_read_b64_tr_b16 v[34:35], v17
  s_waitcnt lgkmcnt(0)
  buffer_store_dwordx4 v[32:35], v4, s[4:7], s28 offen
  v_mov_b32 v11, s16
  v_lshl_add_u32 v11, v11, 2, v5
  v_mul_u32_u24 v12, 52, v11
  v_lshrrev_b32 v12, 8, v12
  v_mul_u32_u24 v13, 5, v12
  v_sub_u32 v13, v11, v13
  v_mul_u32_u24 v12, 40, v12
  v_add_u32 v12, v12, v6
  v_lshlrev_b32 v14, 3, v13
  v_add_u32 v15, 4, v14
  v_cmp_gt_u32 vcc, 2, v13
  s_nop 1
  v_cndmask_b32 v14, v15, v14, vcc
  v_mov_b32 v15, 16
  v_cmp_eq_u32 vcc, 4, v13
  s_nop 1
  v_cndmask_b32 v14, v14, v15, vcc
  v_add_u32 v20, v12, v14
  v_mov_b32 v15, 20
  v_cndmask_b32 v15, 4, v15, vcc
  v_add_u32 v21, v20, v15
  v_mul_u32_u24 v13, 171, v20
  v_lshrrev_b32 v13, 10, v13
  v_mul_u32_u24 v12, 6, v13
  v_sub_u32 v12, v20, v12
  v_mul_u32_u24 v12, 160, v12
  v_lshl_add_u32 v12, v13, 10, v12
  v_mul_u32_u24 v13, 171, v21
  v_lshrrev_b32 v13, 10, v13
  v_mul_u32_u24 v14, 6, v13
  v_sub_u32 v14, v21, v14
  v_mul_u32_u24 v14, 160, v14
  v_lshl_add_u32 v14, v13, 10, v14
  s_mul_i32 s28, s22, 5
  s_add_u32 s28, s28, s16
  s_cmp_ge_u32 s28, 10
  s_cselect_b32 s29, 5, 0
  s_cselect_b32 s30, 10, 0
  s_sub_u32 s28, s28, s30
  s_mul_i32 s28, s28, 10
  s_add_u32 s28, s28, s29
  s_add_u32 s28, s28, 4
  s_lshl_b32 s28, s28, 10
  s_add_u32 s28, s28, s27
  v_add_u32 v16, v12, v23
  v_add_u32 v17, v14, v23
  ds_read_b64_tr_b16 v[32:33], v16
  ds_read_b64_tr_b16 v[34:35], v17
  s_waitcnt lgkmcnt(0)
  buffer_store_dwordx4 v[32:35], v4, s[4:7], s28 offen
  s_endpgm
P0_X:
  s_waitcnt lgkmcnt(0)
  s_mov_b32 s4, s54
  s_mov_b32 s5, s55
  s_mov_b32 s6, 0x10000000
  s_mov_b32 s7, 0x20000
  s_mov_b32 s8, s40
  s_mov_b32 s9, s41
  s_mov_b32 s10, 0x280000
  s_mov_b32 s11, 0x20000
  s_sub_u32 s20, s2, 448
  s_getpc_b64 s[24:25]
P0_PC:
  s_add_u32 s24, s24, (hedgehog_main_kernel-P0_PC)
  s_addc_u32 s25, s25, 0
  v_lshlrev_b32 v100, 7, v0
  v_mov_b32 v101, (M_CODE_END-hedgehog_main_kernel-4)
  v_add_u32 v102, 0x8000, v100
  v_min_u32 v100, v100, v101
  v_min_u32 v102, v102, v101
  v_and_b32 v100, -4, v100
  v_and_b32 v102, -4, v102
  global_load_dword v103, v100, s[24:25]
  global_load_dword v104, v102, s[24:25]
  v_and_b32 v5, 31, v2
  v_lshrrev_b32 v6, 5, v2
  v_mul_u32_u24 v7, 1280, v5
  v_lshl_add_u32 v7, v6, 4, v7
  s_mul_i32 s21, s20, 40960
  s_mul_i32 s22, s16, 320
  s_add_u32 s21, s21, s22
  buffer_load_dwordx4 v[32:35], v7, s[8:11], s21 offen offset:0
  buffer_load_dwordx4 v[36:39], v7, s[8:11], s21 offen offset:32
  buffer_load_dwordx4 v[40:43], v7, s[8:11], s21 offen offset:64
  buffer_load_dwordx4 v[44:47], v7, s[8:11], s21 offen offset:96
  buffer_load_dwordx4 v[48:51], v7, s[8:11], s21 offen offset:128
  buffer_load_dwordx4 v[52:55], v7, s[8:11], s21 offen offset:160
  buffer_load_dwordx4 v[56:59], v7, s[8:11], s21 offen offset:192
  buffer_load_dwordx4 v[60:63], v7, s[8:11], s21 offen offset:224
  buffer_load_dwordx4 v[64:67], v7, s[8:11], s21 offen offset:256
  buffer_load_dwordx4 v[68:71], v7, s[8:11], s21 offen offset:288
  s_mul_i32 s22, s20, 40
  s_mul_i32 s23, s16, 10
  s_add_u32 s22, s22, s23
  s_lshl_b32 s22, s22, 10
  s_add_u32 s22, s22, 0xa00000
  v_mov_b32 v20, 0
  v_mov_b32 v21, 0
  v_mov_b32 v22, 0
  v_mov_b32 v23, 0
  s_add_u32 s23, s22, 0
  s_waitcnt vmcnt(9)
  buffer_store_dwordx4 v[32:35], v4, s[4:7], s23 offen
  v_dot2c_f32_bf16 v20, v32, v3
  v_dot2c_f32_bf16 v21, v32, v32
  v_dot2c_f32_bf16 v20, v33, v3
  v_dot2c_f32_bf16 v21, v33, v33
  v_dot2c_f32_bf16 v20, v34, v3
  v_dot2c_f32_bf16 v21, v34, v34
  v_dot2c_f32_bf16 v20, v35, v3
  v_dot2c_f32_bf16 v21, v35, v35
  s_add_u32 s23, s22, 1024
  s_waitcnt vmcnt(9)
  buffer_store_dwordx4 v[36:39], v4, s[4:7], s23 offen
  v_dot2c_f32_bf16 v20, v36, v3
  v_dot2c_f32_bf16 v21, v36, v36
  v_dot2c_f32_bf16 v20, v37, v3
  v_dot2c_f32_bf16 v21, v37, v37
  v_dot2c_f32_bf16 v20, v38, v3
  v_dot2c_f32_bf16 v21, v38, v38
  v_dot2c_f32_bf16 v20, v39, v3
  v_dot2c_f32_bf16 v21, v39, v39
  s_add_u32 s23, s22, 2048
  s_waitcnt vmcnt(9)
  buffer_store_dwordx4 v[40:43], v4, s[4:7], s23 offen
  v_dot2c_f32_bf16 v20, v40, v3
  v_dot2c_f32_bf16 v21, v40, v40
  v_dot2c_f32_bf16 v20, v41, v3
  v_dot2c_f32_bf16 v21, v41, v41
  v_dot2c_f32_bf16 v20, v42, v3
  v_dot2c_f32_bf16 v21, v42, v42
  v_dot2c_f32_bf16 v20, v43, v3
  v_dot2c_f32_bf16 v21, v43, v43
  s_add_u32 s23, s22, 3072
  s_waitcnt vmcnt(9)
  buffer_store_dwordx4 v[44:47], v4, s[4:7], s23 offen
  v_dot2c_f32_bf16 v20, v44, v3
  v_dot2c_f32_bf16 v21, v44, v44
  v_dot2c_f32_bf16 v20, v45, v3
  v_dot2c_f32_bf16 v21, v45, v45
  v_dot2c_f32_bf16 v20, v46, v3
  v_dot2c_f32_bf16 v21, v46, v46
  v_dot2c_f32_bf16 v20, v47, v3
  v_dot2c_f32_bf16 v21, v47, v47
  s_add_u32 s23, s22, 4096
  s_waitcnt vmcnt(9)
  buffer_store_dwordx4 v[48:51], v4, s[4:7], s23 offen
  v_dot2c_f32_bf16 v20, v48, v3
  v_dot2c_f32_bf16 v21, v48, v48
  v_dot2c_f32_bf16 v20, v49, v3
  v_dot2c_f32_bf16 v21, v49, v49
  v_dot2c_f32_bf16 v20, v50, v3
  v_dot2c_f32_bf16 v21, v50, v50
  v_dot2c_f32_bf16 v20, v51, v3
  v_dot2c_f32_bf16 v21, v51, v51
  s_add_u32 s23, s22, 5120
  s_waitcnt vmcnt(9)
  buffer_store_dwordx4 v[52:55], v4, s[4:7], s23 offen
  v_dot2c_f32_bf16 v22, v52, v3
  v_dot2c_f32_bf16 v23, v52, v52
  v_dot2c_f32_bf16 v22, v53, v3
  v_dot2c_f32_bf16 v23, v53, v53
  v_dot2c_f32_bf16 v22, v54, v3
  v_dot2c_f32_bf16 v23, v54, v54
  v_dot2c_f32_bf16 v22, v55, v3
  v_dot2c_f32_bf16 v23, v55, v55
  s_add_u32 s23, s22, 6144
  s_waitcnt vmcnt(9)
  buffer_store_dwordx4 v[56:59], v4, s[4:7], s23 offen
  v_dot2c_f32_bf16 v22, v56, v3
  v_dot2c_f32_bf16 v23, v56, v56
  v_dot2c_f32_bf16 v22, v57, v3
  v_dot2c_f32_bf16 v23, v57, v57
  v_dot2c_f32_bf16 v22, v58, v3
  v_dot2c_f32_bf16 v23, v58, v58
  v_dot2c_f32_bf16 v22, v59, v3
  v_dot2c_f32_bf16 v23, v59, v59
  s_add_u32 s23, s22, 7168
  s_waitcnt vmcnt(9)
  buffer_store_dwordx4 v[60:63], v4, s[4:7], s23 offen
  v_dot2c_f32_bf16 v22, v60, v3
  v_dot2c_f32_bf16 v23, v60, v60
  v_dot2c_f32_bf16 v22, v61, v3
  v_dot2c_f32_bf16 v23, v61, v61
  v_dot2c_f32_bf16 v22, v62, v3
  v_dot2c_f32_bf16 v23, v62, v62
  v_dot2c_f32_bf16 v22, v63, v3
  v_dot2c_f32_bf16 v23, v63, v63
  s_add_u32 s23, s22, 8192
  s_waitcnt vmcnt(9)
  buffer_store_dwordx4 v[64:67], v4, s[4:7], s23 offen
  v_dot2c_f32_bf16 v22, v64, v3
  v_dot2c_f32_bf16 v23, v64, v64
  v_dot2c_f32_bf16 v22, v65, v3
  v_dot2c_f32_bf16 v23, v65, v65
  v_dot2c_f32_bf16 v22, v66, v3
  v_dot2c_f32_bf16 v23, v66, v66
  v_dot2c_f32_bf16 v22, v67, v3
  v_dot2c_f32_bf16 v23, v67, v67
  s_add_u32 s23, s22, 9216
  s_waitcnt vmcnt(9)
  buffer_store_dwordx4 v[68:71], v4, s[4:7], s23 offen
  v_dot2c_f32_bf16 v22, v68, v3
  v_dot2c_f32_bf16 v23, v68, v68
  v_dot2c_f32_bf16 v22, v69, v3
  v_dot2c_f32_bf16 v23, v69, v69
  v_dot2c_f32_bf16 v22, v70, v3
  v_dot2c_f32_bf16 v23, v70, v70
  v_dot2c_f32_bf16 v22, v71, v3
  v_dot2c_f32_bf16 v23, v71, v71
  v_mov_b32 v24, v20
  s_nop 1
  v_permlane32_swap_b32 v20, v24
  v_add_f32 v20, v20, v24
  v_mov_b32 v24, v21
  s_nop 1
  v_permlane32_swap_b32 v21, v24
  v_add_f32 v21, v21, v24
  v_mov_b32 v24, v22
  s_nop 1
  v_permlane32_swap_b32 v22, v24
  v_add_f32 v22, v22, v24
  v_mov_b32 v24, v23
  s_nop 1
  v_permlane32_swap_b32 v23, v24
  v_add_f32 v23, v23, v24
  v_lshlrev_b32 v8, 3, v5
  v_mov_b32 v9, 0x40000000
  v_cmp_eq_u32 vcc, 0, v6
  s_nop 1
  v_cndmask_b32 v8, v9, v8, vcc
  s_lshl_b32 s23, s20, 8
  s_lshl_b32 s24, s16, 15
  s_add_u32 s23, s23, s24
  s_add_u32 s23, s23, 0xc80000
  buffer_store_dwordx2 v[20:21], v8, s[4:7], s23 offen
  s_add_u32 s23, s23, 16384
  buffer_store_dwordx2 v[22:23], v8, s[4:7], s23 offen
  s_endpgm
P0_END:
  s_endpgm
.text
.globl hedgehog_main_kernel
.p2align 8
.type hedgehog_main_kernel,@function
hedgehog_main_kernel:
  s_cmp_ge_u32 s2, 256
  s_cbranch_scc1 M_END
  s_load_dwordx2 s[32:33], s[0:1], 0
  s_load_dwordx2 s[34:35], s[0:1], 64
  s_load_dwordx2 s[36:37], s[0:1], 80
  v_lshrrev_b32 v10, 6, v0
  v_and_b32 v2, 63, v0
  v_readfirstlane_b32 s16, v10
  v_lshlrev_b32 v1, 4, v2
  s_and_b32 s17, s2, 3
  s_lshr_b32 s26, s2, 6
  s_lshl_b32 s26, s26, 2
  s_or_b32 s17, s17, s26
  s_lshr_b32 s18, s2, 2
  s_and_b32 s18, s18, 15
  s_lshr_b32 s43, s18, 1
  s_and_b32 s44, s18, 1
  s_mul_i32 s21, s16, 5120
  s_lshr_b32 s47, s16, 1
  s_mul_i32 s22, s18, 163840
  s_add_u32 s22, s22, s21
  s_add_u32 s22, s22, 0x10000
  s_mul_i32 s23, s43, 102400
  s_add_u32 s23, s23, s21
  s_add_u32 s23, s23, 0x2a0000
  s_mul_i32 s24, s18, 245760
  s_add_u32 s24, s24, s21
  s_add_u32 s24, s24, 0x368000
  s_mul_i32 s25, s43, 245760
  s_add_u32 s25, s25, s21
  s_add_u32 s25, s25, 0x758000
  s_lshl_b32 s45, s17, 3
  s_lshl_b32 s26, s44, 2
  s_add_u32 s45, s45, s26
  s_and_b32 s26, s16, 1
  s_lshl_b32 s26, s26, 1
  s_add_u32 s45, s45, s26
  s_add_u32 s45, s45, s47
  s_xor_b32 s46, s45, 1
  s_mov_b32 s40, 0
  s_mov_b32 s19, 0
  s_mov_b32 s20, 0xa00000
  s_mov_b32 s3, 0x1000
  s_mov_b32 s38, 1
  s_sub_u32 s56, s16, 1
  s_lshl_b32 s56, s56, 11
  s_sub_u32 s57, s56, s21
  v_mov_b32 v3, 0x3f803f80
  v_mov_b32 v4, 0
  v_mov_b32 v5, 1
  s_waitcnt lgkmcnt(0)
  s_mov_b32 s4, s36
  s_mov_b32 s5, s37
  s_mov_b32 s6, 0x10000000
  s_mov_b32 s7, 0x20000
  s_mov_b32 s8, s32
  s_mov_b32 s9, s33
  s_mov_b32 s10, 0x280000
  s_mov_b32 s11, 0x20000
  s_mov_b32 s12, s34
  s_mov_b32 s13, s35
  s_mov_b32 s14, 0x280000
  s_mov_b32 s15, 0x20000
  s_add_u32 m0, s21, 0
  s_add_u32 s48, s22, 0
  buffer_load_dwordx4 v1, s[4:7], s48 offen lds
  buffer_load_dwordx4 v1, s[4:7], s48 offen offset:1024 lds
  buffer_load_dwordx4 v1, s[4:7], s48 offen offset:2048 lds
  buffer_load_dwordx4 v1, s[4:7], s48 offen offset:3072 lds
  s_add_u32 m0, s21, 4096
  s_add_u32 s48, s22, 4096
  buffer_load_dwordx4 v1, s[4:7], s48 offen lds
  s_add_u32 m0, s21, 20480
  s_add_u32 s48, s22, 20480
  buffer_load_dwordx4 v1, s[4:7], s48 offen lds
  buffer_load_dwordx4 v1, s[4:7], s48 offen offset:1024 lds
  buffer_load_dwordx4 v1, s[4:7], s48 offen offset:2048 lds
  buffer_load_dwordx4 v1, s[4:7], s48 offen offset:3072 lds
  s_add_u32 m0, s21, 24576
  s_add_u32 s48, s22, 24576
  buffer_load_dwordx4 v1, s[4:7], s48 offen lds
  s_cmp_eq_u32 s16, 0
  s_cbranch_scc1 M_side_1
  s_add_u32 m0, s21, 40960
  s_add_u32 s48, s22, 40960
  buffer_load_dwordx4 v1, s[4:7], s48 offen lds
  buffer_load_dwordx4 v1, s[4:7], s48 offen offset:1024 lds
  buffer_load_dwordx4 v1, s[4:7], s48 offen offset:2048 lds
  buffer_load_dwordx4 v1, s[4:7], s48 offen offset:3072 lds
  s_add_u32 m0, s21, 45056
  s_add_u32 s48, s22, 45056
  buffer_load_dwordx4 v1, s[4:7], s48 offen lds
  s_add_u32 m0, s56, 40960
  s_add_u32 s48, s22, 40960
  s_add_u32 s48, s48, s57
  buffer_load_dwordx4 v1, s[4:7], s48 offen lds
  buffer_load_dwordx4 v1, s[4:7], s48 offen offset:1024 lds
M_side_1:
  s_cmp_eq_u32 s16, 0
  s_cbranch_scc1 M_side_2
M_side_2:
M_LAYER:
  s_cmp_eq_u32 s19, 0
  s_cbranch_scc1 M_a_nopoll_3
  s_mul_i32 s26, s17, 128
  s_add_u32 s26, s26, s3
  s_add_u32 s26, s26, 0x0
  s_cmp_lg_u32 s16, 0
  s_cbranch_scc1 M_got_5
  s_cmp_lg_u32 s40, 0
  s_cbranch_scc1 M_got_5
  s_mov_b32 s41, 0
M_poll_4:
  buffer_load_dword v6, v4, s[4:7], s26 offen sc1
  s_waitcnt vmcnt(0)
  v_cmp_gt_u32 vcc, 16, v6
  s_nop 4
  s_cbranch_vccz M_got_5
  s_add_u32 s41, s41, 1
  s_cmp_lt_u32 s41, 40000
  s_cbranch_scc1 M_poll_4
  s_mov_b32 s40, 1
M_got_5:
  s_barrier
M_a_nopoll_3:
  s_lshl_b32 s26, s17, 2
  s_add_u32 s26, s26, s16
  s_mul_i32 s49, s26, 40960
  s_add_u32 s49, s49, s20
  s_add_u32 s49, s49, 0x0
  s_add_u32 s50, s49, 0
  buffer_load_dwordx4 a[0:3], v1, s[4:7], s50 offen offset:0 sc1
  buffer_load_dwordx4 a[4:7], v1, s[4:7], s50 offen offset:1024 sc1
  buffer_load_dwordx4 a[8:11], v1, s[4:7], s50 offen offset:2048 sc1
  buffer_load_dwordx4 a[12:15], v1, s[4:7], s50 offen offset:3072 sc1
  s_add_u32 s50, s49, 4096
  buffer_load_dwordx4 a[16:19], v1, s[4:7], s50 offen offset:0 sc1
  buffer_load_dwordx4 a[20:23], v1, s[4:7], s50 offen offset:1024 sc1
  buffer_load_dwordx4 a[24:27], v1, s[4:7], s50 offen offset:2048 sc1
  buffer_load_dwordx4 a[28:31], v1, s[4:7], s50 offen offset:3072 sc1
  s_add_u32 s50, s49, 8192
  buffer_load_dwordx4 a[32:35], v1, s[4:7], s50 offen offset:0 sc1
  buffer_load_dwordx4 a[36:39], v1, s[4:7], s50 offen offset:1024 sc1
  buffer_load_dwordx4 a[40:43], v1, s[4:7], s50 offen offset:2048 sc1
  buffer_load_dwordx4 a[44:47], v1, s[4:7], s50 offen offset:3072 sc1
  s_cmp_eq_u32 s38, 0
  s_cbranch_scc1 M_lanes_6
  v_add_u32 v7, 61440, v1
  v_lshlrev_b32 v220, 7, v2
  s_mul_i32 s26, s47, 5120
  v_add_u32 v8, s26, v1
  v_add_u32 v9, 61440, v8
  v_add_u32 v218, 122880, v8
  v_and_b32 v100, 31, v2
  v_lshrrev_b32 v101, 5, v2
  v_and_b32 v102, 15, v2
  v_lshrrev_b32 v103, 4, v2
  v_mov_b32 v104, 0x40000000
  v_lshlrev_b32 v224, 3, v100
  v_lshl_add_u32 v224, v101, 16, v224
  s_lshl_b32 s26, s16, 5
  v_add_u32 v105, s26, v100
  v_mul_u32_u24 v105, 144, v105
  v_mul_u32_u24 v106, 18432, v101
  v_add_u32 v105, v105, v106
  v_add_u32 v225, 0x1e000, v105
  v_lshrrev_b32 v105, 1, v103
  v_bfe_u32 v106, v2, 2, 2
  v_lshl_add_u32 v105, v105, 3, v106
  v_mul_u32_u24 v105, 144, v105
  v_and_b32 v106, 1, v103
  v_lshlrev_b32 v106, 5, v106
  v_and_b32 v107, 3, v2
  v_lshl_add_u32 v106, v107, 3, v106
  v_add_u32 v105, v105, v106
  s_lshr_b32 s26, s16, 1
  s_mul_i32 s26, s26, 18432
  s_add_u32 s26, s26, 0x1e000
  s_and_b32 s27, s16, 1
  s_mul_i32 s28, s27, 40
  s_add_u32 s28, s28, s26
  s_add_u32 s29, s26, 80
  v_add_u32 v226, s28, v105
  v_add_u32 v227, s29, v105
  s_lshl_b32 s26, s16, 10
  v_mul_u32_u24 v105, 24, v101
  v_add_u32 v105, v105, v100
  v_lshlrev_b32 v105, 4, v105
  v_add_u32 v105, s26, v105
  v_cmp_gt_u32 vcc, 24, v100
  s_nop 1
  v_cndmask_b32 v228, v104, v105, vcc
  v_lshlrev_b32 v105, 3, v100
  v_add_u32 v105, s26, v105
  v_add_u32 v105, 768, v105
  v_cmp_eq_u32 vcc, 0, v101
  s_nop 1
  v_cndmask_b32 v229, v104, v105, vcc
  v_mov_b32 v106, 84
  v_cmp_le_u32 s[30:31], v106, v0
  s_nop 1
  v_cndmask_b32 v106, 0, 1, s[30:31]
  v_mul_u32_u24 v107, 84, v106
  v_sub_u32 v107, v0, v107
  v_mul_u32_u24 v108, 391, v107
  v_lshrrev_b32 v108, 13, v108
  v_mul_u32_u24 v109, 21, v108
  v_sub_u32 v109, v107, v109
  v_subrev_u32 v110, 168, v0
  v_mul_u32_u24 v111, 391, v110
  v_lshrrev_b32 v111, 13, v111
  v_and_b32 v111, 3, v111
  v_mul_u32_u24 v96, 21, v111
  v_sub_u32 v96, v110, v96
  v_cmp_gt_u32 vcc, 168, v0
  v_lshrrev_b32 v97, 1, v108
  v_lshl_add_u32 v97, v106, 1, v97
  v_lshlrev_b32 v97, 10, v97
  v_and_b32 v98, 1, v108
  v_mul_u32_u24 v98, 24, v98
  v_add_u32 v98, v98, v109
  v_lshl_add_u32 v97, v98, 4, v97
  v_lshlrev_b32 v98, 10, v111
  v_lshl_add_u32 v98, v96, 3, v98
  v_add_u32 v98, 768, v98
  v_cndmask_b32 v97, v98, v97, vcc
  v_mov_b32 v99, 252
  v_cmp_gt_u32 s[30:31], v99, v0
  s_nop 1
  v_cndmask_b32 v230, v104, v97, s[30:31]
  v_lshrrev_b32 v97, 1, v111
  v_cndmask_b32 v106, v97, v106, vcc
  v_cndmask_b32 v108, 4, v108, vcc
  v_cndmask_b32 v109, v96, v109, vcc
  v_lshrrev_b32 v110, 4, v109
  v_mul_u32_u24 v110, 5, v110
  v_add_u32 v110, v110, v108
  v_and_b32 v109, 15, v109
  v_lshrrev_b32 v97, 2, v109
  v_lshlrev_b32 v97, 3, v97
  v_and_b32 v109, 3, v109
  v_add_u32 v97, v97, v109
  v_mul_u32_u24 v109, 36, v106
  v_add_u32 v97, v97, v109
  v_lshlrev_b32 v97, 4, v97
  v_lshl_add_u32 v97, v110, 10, v97
  v_add_u32 v97, 0x1e000, v97
  v_and_b32 v105, 63, v0
  v_lshlrev_b32 v105, 4, v105
  v_add_u32 v105, 0x21000, v105
  v_cndmask_b32 v231, v105, v97, vcc
  v_and_b32 v98, 1, v111
  v_lshl_add_u32 v97, v98, 3, v97
  v_cndmask_b32 v97, v97, v105, vcc
  v_cndmask_b32 v221, v105, v97, s[30:31]
  s_mul_i32 s26, s18, 5
  v_bfe_u32 v105, v2, 4, 1
  v_mul_u32_u24 v105, 20480, v105
  v_lshl_add_u32 v105, v102, 4, v105
  v_lshl_add_u32 v106, v101, 1, s26
  v_add_u32 v106, 0, v106
  v_lshrrev_b32 v107, 2, v106
  v_lshl_add_u32 v107, v107, 10, v105
  v_and_b32 v106, 3, v106
  v_lshl_add_u32 v232, v106, 8, v107
  v_lshl_add_u32 v106, v101, 1, s26
  v_add_u32 v106, 1, v106
  v_lshrrev_b32 v107, 2, v106
  v_lshl_add_u32 v107, v107, 10, v105
  v_and_b32 v106, 3, v106
  v_lshl_add_u32 v233, v106, 8, v107
  v_mov_b32 v106, s26
  v_add_u32 v106, 4, v106
  v_lshrrev_b32 v107, 2, v106
  v_lshl_add_u32 v107, v107, 10, v105
  v_and_b32 v106, 3, v106
  v_lshl_add_u32 v234, v106, 8, v107
  v_lshl_add_u32 v234, v101, 3, v234
  s_mul_i32 s26, s43, 10
  s_and_b32 s27, s45, 1
  s_lshl_b32 s27, s27, 8
  v_lshlrev_b32 v105, 4, v102
  v_add_u32 v106, s26, v103
  v_add_u32 v106, 0, v106
  v_lshrrev_b32 v107, 2, v106
  v_lshl_add_u32 v107, v107, 10, v105
  v_and_b32 v108, 3, v106
  v_lshl_add_u32 v235, v108, 8, v107
  v_lshrrev_b32 v107, 1, v106
  v_lshl_add_u32 v107, v107, 10, v105
  v_and_b32 v108, 1, v106
  v_lshl_add_u32 v107, v108, 9, v107
  v_add_u32 v238, s27, v107
  v_add_u32 v106, s26, v103
  v_add_u32 v106, 4, v106
  v_lshrrev_b32 v107, 2, v106
  v_lshl_add_u32 v107, v107, 10, v105
  v_and_b32 v108, 3, v106
  v_lshl_add_u32 v236, v108, 8, v107
  v_lshrrev_b32 v107, 1, v106
  v_lshl_add_u32 v107, v107, 10, v105
  v_and_b32 v108, 1, v106
  v_lshl_add_u32 v107, v108, 9, v107
  v_add_u32 v239, s27, v107
  v_lshrrev_b32 v106, 1, v103
  v_add_u32 v106, s26, v106
  v_add_u32 v106, 8, v106
  v_lshrrev_b32 v107, 2, v106
  v_lshl_add_u32 v107, v107, 10, v105
  v_and_b32 v108, 3, v106
  v_lshl_add_u32 v237, v108, 8, v107
  v_lshrrev_b32 v107, 1, v106
  v_lshl_add_u32 v107, v107, 10, v105
  v_and_b32 v108, 1, v106
  v_lshl_add_u32 v107, v108, 9, v107
  v_add_u32 v250, s27, v107
  v_and_b32 v106, 1, v103
  v_lshl_add_u32 v237, v106, 3, v237
  v_lshl_add_u32 v250, v106, 3, v250
  v_mul_u32_u24 v105, 1280, v102
  v_lshl_add_u32 v251, v103, 4, v105
  v_lshl_add_u32 v252, v103, 3, v105
  v_add_u32 v252, 128, v252
  v_lshlrev_b32 v105, 3, v102
  v_cmp_eq_u32 vcc, 0, v103
  s_nop 1
  v_cndmask_b32 v253, v104, v105, vcc
  v_lshl_add_u32 v254, v103, 15, v105
  s_add_u32 s26, s21, 0x1e000
  v_add_u32 v255, s26, v1
  s_xor_b32 s27, s16, 2
  s_mul_i32 s27, s27, 5120
  s_add_u32 s27, s27, 0x1e000
  v_add_u32 v15, s27, v1
  s_mov_b32 s38, 0
M_lanes_6:
  s_lshl_b32 s26, s17, 2
  s_add_u32 s26, s26, s16
  s_lshl_b32 s27, s26, 8
  s_add_u32 s27, s27, s20
  s_add_u32 s27, s27, 0x280000
  s_lshl_b32 s28, s18, 12
  s_add_u32 s28, s28, 0x290000
  s_waitcnt vmcnt(17)
  s_waitcnt vmcnt(12)
  s_barrier
  ds_read_b128 v[16:19], v1 offset:0
  ds_read_b128 v[20:23], v1 offset:1024
  ds_read_b128 v[24:27], v1 offset:2048
  ds_read_b128 v[28:31], v1 offset:3072
  ds_read_b128 v[32:35], v1 offset:4096
  s_waitcnt vmcnt(11) lgkmcnt(4)
  v_mfma_f32_32x32x16_bf16 v[48:63], v[16:19], a[0:3], 0
  ds_read_b128 v[36:39], v1 offset:5120
  s_waitcnt lgkmcnt(4)
  s_add_u32 s50, s49, 12288
  buffer_load_dwordx4 a[48:51], v1, s[4:7], s50 offen offset:0 sc1
  v_mfma_f32_32x32x16_bf16 v[64:79], v[20:23], a[0:3], 0
  ds_read_b128 v[40:43], v1 offset:6144
  s_waitcnt lgkmcnt(4)
  buffer_load_dwordx4 a[52:55], v1, s[4:7], s50 offen offset:1024 sc1
  s_add_u32 m0, s21, 61440
  s_add_u32 s48, s22, 61440
  v_mfma_f32_32x32x16_bf16 v[80:95], v[24:27], a[0:3], 0
  ds_read_b128 v[44:47], v1 offset:7168
  s_waitcnt lgkmcnt(4)
  buffer_load_dwordx4 v1, s[4:7], s48 offen lds
  s_waitcnt vmcnt(13)
  v_mfma_f32_32x32x16_bf16 v[48:63], v[28:31], a[4:7], v[48:63]
  ds_read_b128 v[16:19], v1 offset:8192
  s_waitcnt lgkmcnt(4)
  buffer_load_dwordx4 v1, s[4:7], s48 offen offset:1024 lds
  v_mfma_f32_32x32x16_bf16 v[64:79], v[32:35], a[4:7], v[64:79]
  ds_read_b128 v[20:23], v1 offset:9216
  s_waitcnt lgkmcnt(4)
  buffer_load_dwordx4 v1, s[4:7], s48 offen offset:2048 lds
  v_mfma_f32_32x32x16_bf16 v[80:95], v[36:39], a[4:7], v[80:95]
  ds_read_b128 v[24:27], v1 offset:10240
  s_waitcnt lgkmcnt(4)
  buffer_load_dwordx4 v1, s[4:7], s48 offen offset:3072 lds
  s_add_u32 m0, s21, 65536
  s_add_u32 s48, s22, 65536
  s_waitcnt vmcnt(15)
  v_mfma_f32_32x32x16_bf16 v[48:63], v[40:43], a[8:11], v[48:63]
  ds_read_b128 v[28:31], v1 offset:11264
  s_waitcnt lgkmcnt(4)
  buffer_load_dwordx4 v1, s[4:7], s48 offen lds
  v_mfma_f32_32x32x16_bf16 v[64:79], v[44:47], a[8:11], v[64:79]
  ds_read_b128 v[32:35], v1 offset:12288
  s_waitcnt lgkmcnt(4)
  buffer_load_dwordx4 a[56:59], v1, s[4:7], s50 offen offset:2048 sc1
  v_mfma_f32_32x32x16_bf16 v[80:95], v[16:19], a[8:11], v[80:95]
  ds_read_b128 v[36:39], v1 offset:13312
  s_waitcnt lgkmcnt(4)
  buffer_load_dwordx4 a[60:63], v1, s[4:7], s50 offen offset:3072 sc1
  s_add_u32 s50, s49, 16384
  s_waitcnt vmcnt(17)
  v_mfma_f32_32x32x16_bf16 v[48:63], v[20:23], a[12:15], v[48:63]
  ds_read_b128 v[40:43], v1 offset:14336
  s_waitcnt lgkmcnt(4)
  buffer_load_dwordx4 a[64:67], v1, s[4:7], s50 offen offset:0 sc1
  v_mfma_f32_32x32x16_bf16 v[64:79], v[24:27], a[12:15], v[64:79]
  ds_read_b128 v[44:47], v1 offset:15360
  s_waitcnt lgkmcnt(4)
  buffer_load_dwordx4 a[68:71], v1, s[4:7], s50 offen offset:1024 sc1
  v_mfma_f32_32x32x16_bf16 v[80:95], v[28:31], a[12:15], v[80:95]
  ds_read_b128 v[16:19], v1 offset:16384
  s_waitcnt lgkmcnt(4)
  buffer_load_dwordx4 a[72:75], v1, s[4:7], s50 offen offset:2048 sc1
  s_waitcnt vmcnt(19)
  v_mfma_f32_32x32x16_bf16 v[48:63], v[32:35], a[16:19], v[48:63]
  ds_read_b128 v[20:23], v1 offset:17408
  s_waitcnt lgkmcnt(4)
  buffer_load_dwordx4 a[76:79], v1, s[4:7], s50 offen offset:3072 sc1
  s_add_u32 s50, s49, 20480
  v_mfma_f32_32x32x16_bf16 v[64:79], v[36:39], a[16:19], v[64:79]
  ds_read_b128 v[24:27], v1 offset:18432
  s_waitcnt lgkmcnt(4)
  buffer_load_dwordx4 a[80:83], v1, s[4:7], s50 offen offset:0 sc1
  s_add_u32 m0, s21, 81920
  s_add_u32 s48, s22, 81920
  v_mfma_f32_32x32x16_bf16 v[80:95], v[40:43], a[16:19], v[80:95]
  ds_read_b128 v[28:31], v1 offset:19456
  s_waitcnt lgkmcnt(4)
  buffer_load_dwordx4 v1, s[4:7], s48 offen lds
  s_waitcnt vmcnt(21)
  v_mfma_f32_32x32x16_bf16 v[48:63], v[44:47], a[20:23], v[48:63]
  ds_read_b128 v[32:35], v1 offset:20480
  s_waitcnt lgkmcnt(4)
  buffer_load_dwordx4 v1, s[4:7], s48 offen offset:1024 lds
  v_mfma_f32_32x32x16_bf16 v[64:79], v[16:19], a[20:23], v[64:79]
  ds_read_b128 v[36:39], v1 offset:21504
  s_waitcnt lgkmcnt(4)
  buffer_load_dwordx4 v1, s[4:7], s48 offen offset:2048 lds
  v_mfma_f32_32x32x16_bf16 v[80:95], v[20:23], a[20:23], v[80:95]
  ds_read_b128 v[40:43], v1 offset:22528
  s_waitcnt lgkmcnt(4)
  buffer_load_dwordx4 v1, s[4:7], s48 offen offset:3072 lds
  s_add_u32 m0, s21, 86016
  s_add_u32 s48, s22, 86016
  s_waitcnt vmcnt(23)
  v_mfma_f32_32x32x16_bf16 v[48:63], v[24:27], a[24:27], v[48:63]
  ds_read_b128 v[44:47], v1 offset:23552
  s_waitcnt lgkmcnt(4)
  buffer_load_dwordx4 v1, s[4:7], s48 offen lds
  v_mfma_f32_32x32x16_bf16 v[64:79], v[28:31], a[24:27], v[64:79]
  ds_read_b128 v[16:19], v1 offset:24576
  s_waitcnt lgkmcnt(4)
  buffer_load_dwordx4 a[84:87], v1, s[4:7], s50 offen offset:1024 sc1
  s_barrier
  v_mfma_f32_32x32x16_bf16 v[80:95], v[32:35], a[24:27], v[80:95]
  ds_read_b128 v[20:23], v1 offset:25600
  s_waitcnt lgkmcnt(4)
  buffer_load_dwordx2 v[112:113], v224, s[4:7], s27 offen sc1
  s_add_u32 s27, s27, 16384
  s_waitcnt vmcnt(25)
  v_mfma_f32_32x32x16_bf16 v[48:63], v[36:39], a[28:31], v[48:63]
  ds_read_b128 v[24:27], v1 offset:26624
  s_waitcnt lgkmcnt(4)
  buffer_load_dwordx2 v[114:115], v224, s[4:7], s27 offen sc1
  s_add_u32 s27, s27, 16384
  v_mfma_f32_32x32x16_bf16 v[64:79], v[40:43], a[28:31], v[64:79]
  ds_read_b128 v[28:31], v1 offset:27648
  s_waitcnt lgkmcnt(4)
  buffer_load_dwordx2 v[116:117], v224, s[4:7], s27 offen sc1
  s_add_u32 s27, s27, 16384
  v_mfma_f32_32x32x16_bf16 v[80:95], v[44:47], a[28:31], v[80:95]
  ds_read_b128 v[32:35], v1 offset:28672
  s_waitcnt lgkmcnt(4)
  buffer_load_dwordx2 v[118:119], v224, s[4:7], s27 offen sc1
  s_waitcnt vmcnt(27)
  v_mfma_f32_32x32x16_bf16 v[48:63], v[16:19], a[32:35], v[48:63]
  ds_read_b128 v[36:39], v1 offset:29696
  s_waitcnt lgkmcnt(4)
  buffer_load_dwordx4 a[88:91], v1, s[4:7], s50 offen offset:2048 sc1
  v_mfma_f32_32x32x16_bf16 v[64:79], v[20:23], a[32:35], v[64:79]
  ds_read_b128 v[40:43], v1 offset:30720
  s_waitcnt lgkmcnt(4)
  buffer_load_dwordx4 a[92:95], v1, s[4:7], s50 offen offset:3072 sc1
  s_add_u32 s50, s49, 24576
  v_mfma_f32_32x32x16_bf16 v[80:95], v[24:27], a[32:35], v[80:95]
  ds_read_b128 v[44:47], v1 offset:31744
  s_waitcnt lgkmcnt(4)
  buffer_load_dwordx4 a[96:99], v1, s[4:7], s50 offen offset:0 sc1
  s_waitcnt vmcnt(29)
  v_mfma_f32_32x32x16_bf16 v[48:63], v[28:31], a[36:39], v[48:63]
  ds_read_b128 v[16:19], v1 offset:32768
  s_waitcnt lgkmcnt(4)
  buffer_load_dwordx4 a[100:103], v1, s[4:7], s50 offen offset:1024 sc1
  v_mfma_f32_32x32x16_bf16 v[64:79], v[32:35], a[36:39], v[64:79]
  ds_read_b128 v[20:23], v1 offset:33792
  s_waitcnt lgkmcnt(4)
  buffer_load_dwordx4 a[104:107], v1, s[4:7], s50 offen offset:2048 sc1
  s_add_u32 m0, s21, 102400
  s_add_u32 s48, s22, 102400
  v_mfma_f32_32x32x16_bf16 v[80:95], v[36:39], a[36:39], v[80:95]
  ds_read_b128 v[24:27], v1 offset:34816
  s_waitcnt lgkmcnt(4)
  buffer_load_dwordx4 v1, s[4:7], s48 offen lds
  s_waitcnt vmcnt(31)
  v_mfma_f32_32x32x16_bf16 v[48:63], v[40:43], a[40:43], v[48:63]
  ds_read_b128 v[28:31], v1 offset:35840
  s_waitcnt lgkmcnt(4)
  buffer_load_dwordx4 v1, s[4:7], s48 offen offset:1024 lds
  v_mfma_f32_32x32x16_bf16 v[64:79], v[44:47], a[40:43], v[64:79]
  ds_read_b128 v[32:35], v1 offset:36864
  s_waitcnt lgkmcnt(4)
  buffer_load_dwordx4 v1, s[4:7], s48 offen offset:2048 lds
  v_mfma_f32_32x32x16_bf16 v[80:95], v[16:19], a[40:43], v[80:95]
  ds_read_b128 v[36:39], v1 offset:37888
  s_waitcnt lgkmcnt(4)
  buffer_load_dwordx4 v1, s[4:7], s48 offen offset:3072 lds
  s_add_u32 m0, s21, 106496
  s_add_u32 s48, s22, 106496
  s_waitcnt vmcnt(33)
  v_mfma_f32_32x32x16_bf16 v[48:63], v[20:23], a[44:47], v[48:63]
  ds_read_b128 v[40:43], v1 offset:38912
  s_waitcnt lgkmcnt(4)
  buffer_load_dwordx4 v1, s[4:7], s48 offen lds
  v_mfma_f32_32x32x16_bf16 v[64:79], v[24:27], a[44:47], v[64:79]
  ds_read_b128 v[44:47], v1 offset:39936
  s_waitcnt lgkmcnt(4)
  buffer_load_dwordx4 a[108:111], v1, s[4:7], s50 offen offset:3072 sc1
  s_add_u32 s50, s49, 28672
  v_mfma_f32_32x32x16_bf16 v[80:95], v[28:31], a[44:47], v[80:95]
  ds_read_b128 v[16:19], v1 offset:40960
  s_waitcnt lgkmcnt(4)
  buffer_load_dwordx4 a[112:115], v1, s[4:7], s50 offen offset:0 sc1
  s_waitcnt vmcnt(35)
  v_mfma_f32_32x32x16_bf16 v[48:63], v[32:35], a[48:51], v[48:63]
  ds_read_b128 v[20:23], v1 offset:41984
  s_waitcnt lgkmcnt(4)
  buffer_load_dwordx4 a[116:119], v1, s[4:7], s50 offen offset:1024 sc1
  v_mfma_f32_32x32x16_bf16 v[64:79], v[36:39], a[48:51], v[64:79]
  ds_read_b128 v[24:27], v1 offset:43008
  s_waitcnt lgkmcnt(4)
  buffer_load_dwordx4 a[120:123], v1, s[4:7], s50 offen offset:2048 sc1
  v_mfma_f32_32x32x16_bf16 v[80:95], v[40:43], a[48:51], v[80:95]
  ds_read_b128 v[28:31], v1 offset:44032
  s_waitcnt lgkmcnt(4)
  buffer_load_dwordx4 v[128:131], v1, s[4:7], s28 offen offset:0
  s_waitcnt vmcnt(37)
  v_mfma_f32_32x32x16_bf16 v[48:63], v[44:47], a[52:55], v[48:63]
  ds_read_b128 v[32:35], v1 offset:45056
  s_waitcnt lgkmcnt(4)
  buffer_load_dwordx4 v[132:135], v1, s[4:7], s28 offen offset:1024
  s_waitcnt vmcnt(33)
  s_barrier
  v_mfma_f32_32x32x16_bf16 v[64:79], v[16:19], a[52:55], v[64:79]
  ds_read_b128 v[36:39], v1 offset:46080
  s_waitcnt lgkmcnt(4)
  buffer_load_dwordx4 v[136:139], v1, s[4:7], s28 offen offset:2048
  v_mfma_f32_32x32x16_bf16 v[80:95], v[20:23], a[52:55], v[80:95]
  ds_read_b128 v[40:43], v1 offset:47104
  s_waitcnt lgkmcnt(4)
  buffer_load_dwordx4 v[140:143], v1, s[4:7], s28 offen offset:3072
  s_waitcnt vmcnt(34)
  v_mfma_f32_32x32x16_bf16 v[48:63], v[24:27], a[56:59], v[48:63]
  ds_read_b128 v[44:47], v1 offset:48128
  s_waitcnt lgkmcnt(4)
  buffer_load_dwordx4 a[124:127], v1, s[4:7], s50 offen offset:3072 sc1
  s_add_u32 s50, s49, 32768
  v_mfma_f32_32x32x16_bf16 v[64:79], v[28:31], a[56:59], v[64:79]
  ds_read_b128 v[16:19], v1 offset:49152
  s_waitcnt lgkmcnt(4)
  buffer_load_dwordx4 a[128:131], v1, s[4:7], s50 offen offset:0 sc1
  v_mfma_f32_32x32x16_bf16 v[80:95], v[32:35], a[56:59], v[80:95]
  ds_read_b128 v[20:23], v1 offset:50176
  s_waitcnt lgkmcnt(4)
  buffer_load_dwordx4 a[132:135], v1, s[4:7], s50 offen offset:1024 sc1
  s_add_u32 m0, s21, 0
  s_add_u32 s48, s22, 122880
  s_waitcnt vmcnt(36)
  v_mfma_f32_32x32x16_bf16 v[48:63], v[36:39], a[60:63], v[48:63]
  ds_read_b128 v[24:27], v1 offset:51200
  s_waitcnt lgkmcnt(4)
  buffer_load_dwordx4 v1, s[4:7], s48 offen lds
  v_mfma_f32_32x32x16_bf16 v[64:79], v[40:43], a[60:63], v[64:79]
  ds_read_b128 v[28:31], v1 offset:52224
  s_waitcnt lgkmcnt(4)
  buffer_load_dwordx4 v1, s[4:7], s48 offen offset:1024 lds
  v_mfma_f32_32x32x16_bf16 v[80:95], v[44:47], a[60:63], v[80:95]
  ds_read_b128 v[32:35], v1 offset:53248
  s_waitcnt lgkmcnt(4)
  buffer_load_dwordx4 v1, s[4:7], s48 offen offset:2048 lds
  s_waitcnt vmcnt(38)
  v_mfma_f32_32x32x16_bf16 v[48:63], v[16:19], a[64:67], v[48:63]
  ds_read_b128 v[36:39], v1 offset:54272
  s_waitcnt lgkmcnt(4)
  buffer_load_dwordx4 v1, s[4:7], s48 offen offset:3072 lds
  s_add_u32 m0, s21, 4096
  s_add_u32 s48, s22, 126976
  v_mfma_f32_32x32x16_bf16 v[64:79], v[20:23], a[64:67], v[64:79]
  ds_read_b128 v[40:43], v1 offset:55296
  s_waitcnt lgkmcnt(4)
  buffer_load_dwordx4 v1, s[4:7], s48 offen lds
  v_mfma_f32_32x32x16_bf16 v[80:95], v[24:27], a[64:67], v[80:95]
  ds_read_b128 v[44:47], v1 offset:56320
  s_waitcnt lgkmcnt(4)
  buffer_load_dwordx4 a[136:139], v1, s[4:7], s50 offen offset:2048 sc1
  s_waitcnt vmcnt(40)
  v_mfma_f32_32x32x16_bf16 v[48:63], v[28:31], a[68:71], v[48:63]
  ds_read_b128 v[16:19], v1 offset:57344
  s_waitcnt lgkmcnt(4)
  buffer_load_dwordx4 a[140:143], v1, s[4:7], s50 offen offset:3072 sc1
  s_add_u32 s50, s49, 36864
  v_mfma_f32_32x32x16_bf16 v[64:79], v[32:35], a[68:71], v[64:79]
  ds_read_b128 v[20:23], v1 offset:58368
  s_waitcnt lgkmcnt(4)
  buffer_load_dwordx4 a[144:147], v1, s[4:7], s50 offen offset:0 sc1
  v_mfma_f32_32x32x16_bf16 v[80:95], v[36:39], a[68:71], v[80:95]
  ds_read_b128 v[24:27], v1 offset:59392
  s_waitcnt lgkmcnt(4)
  buffer_load_dwordx4 a[148:151], v1, s[4:7], s50 offen offset:1024 sc1
  s_waitcnt vmcnt(42)
  v_mfma_f32_32x32x16_bf16 v[48:63], v[40:43], a[72:75], v[48:63]
  ds_read_b128 v[28:31], v1 offset:60416
  s_waitcnt lgkmcnt(4)
  buffer_load_dwordx4 a[152:155], v1, s[4:7], s50 offen offset:2048 sc1
  v_mfma_f32_32x32x16_bf16 v[64:79], v[44:47], a[72:75], v[64:79]
  ds_read_b128 v[32:35], v7 offset:0
  s_waitcnt lgkmcnt(4)
  buffer_load_dwordx4 a[156:159], v1, s[4:7], s50 offen offset:3072 sc1
  s_add_u32 m0, s21, 20480
  s_add_u32 s48, s22, 143360
  v_mfma_f32_32x32x16_bf16 v[80:95], v[16:19], a[72:75], v[80:95]
  ds_read_b128 v[36:39], v7 offset:1024
  s_waitcnt lgkmcnt(4)
  buffer_load_dwordx4 v1, s[4:7], s48 offen lds
  s_waitcnt vmcnt(44)
  v_mfma_f32_32x32x16_bf16 v[48:63], v[20:23], a[76:79], v[48:63]
  ds_read_b128 v[40:43], v7 offset:2048
  s_waitcnt lgkmcnt(4)
  buffer_load_dwordx4 v1, s[4:7], s48 offen offset:1024 lds
  v_mfma_f32_32x32x16_bf16 v[64:79], v[24:27], a[76:79], v[64:79]
  ds_read_b128 v[44:47], v7 offset:3072
  s_waitcnt lgkmcnt(4)
  buffer_load_dwordx4 v1, s[4:7], s48 offen offset:2048 lds
  v_mfma_f32_32x32x16_bf16 v[80:95], v[28:31], a[76:79], v[80:95]
  ds_read_b128 v[16:19], v7 offset:4096
  s_waitcnt lgkmcnt(4)
  buffer_load_dwordx4 v1, s[4:7], s48 offen offset:3072 lds
  s_add_u32 m0, s21, 24576
  s_add_u32 s48, s22, 147456
  s_waitcnt vmcnt(41)
  s_barrier
  v_mfma_f32_32x32x16_bf16 v[48:63], v[32:35], a[80:83], v[48:63]
  ds_read_b128 v[20:23], v7 offset:5120
  s_waitcnt lgkmcnt(4)
  buffer_load_dwordx4 v1, s[4:7], s48 offen lds
  s_add_u32 m0, s21, 40960
  s_add_u32 s48, s23, 0
  v_mfma_f32_32x32x16_bf16 v[64:79], v[36:39], a[80:83], v[64:79]
  ds_read_b128 v[24:27], v7 offset:6144
  s_waitcnt lgkmcnt(4)
  buffer_load_dwordx4 v1, s[4:7], s48 offen lds
  v_mfma_f32_32x32x16_bf16 v[80:95], v[40:43], a[80:83], v[80:95]
  ds_read_b128 v[28:31], v7 offset:7168
  s_waitcnt lgkmcnt(4)
  buffer_load_dwordx4 v1, s[4:7], s48 offen offset:1024 lds
  s_waitcnt vmcnt(43)
  v_mfma_f32_32x32x16_bf16 v[48:63], v[44:47], a[84:87], v[48:63]
  ds_read_b128 v[32:35], v7 offset:8192
  s_waitcnt lgkmcnt(4)
  buffer_load_dwordx4 v1, s[4:7], s48 offen offset:2048 lds
  v_mfma_f32_32x32x16_bf16 v[64:79], v[16:19], a[84:87], v[64:79]
  ds_read_b128 v[36:39], v7 offset:9216
  s_waitcnt lgkmcnt(4)
  buffer_load_dwordx4 v1, s[4:7], s48 offen offset:3072 lds
  s_add_u32 m0, s21, 45056
  s_add_u32 s48, s23, 4096
  v_mfma_f32_32x32x16_bf16 v[80:95], v[20:23], a[84:87], v[80:95]
  ds_read_b128 v[40:43], v7 offset:10240
  s_waitcnt lgkmcnt(4)
  buffer_load_dwordx4 v1, s[4:7], s48 offen lds
  s_waitcnt vmcnt(41)
  v_mfma_f32_32x32x16_bf16 v[48:63], v[24:27], a[88:91], v[48:63]
  ds_read_b128 v[44:47], v7 offset:11264
  s_waitcnt lgkmcnt(4)
  v_mfma_f32_32x32x16_bf16 v[64:79], v[28:31], a[88:91], v[64:79]
  ds_read_b128 v[16:19], v7 offset:12288
  s_waitcnt lgkmcnt(4)
  v_mfma_f32_32x32x16_bf16 v[80:95], v[32:35], a[88:91], v[80:95]
  ds_read_b128 v[20:23], v7 offset:13312
  s_waitcnt lgkmcnt(4)
  s_waitcnt vmcnt(40)
  v_mfma_f32_32x32x16_bf16 v[48:63], v[36:39], a[92:95], v[48:63]
  ds_read_b128 v[24:27], v7 offset:14336
  s_waitcnt lgkmcnt(4)
  v_mfma_f32_32x32x16_bf16 v[64:79], v[40:43], a[92:95], v[64:79]
  ds_read_b128 v[28:31], v7 offset:15360
  s_waitcnt lgkmcnt(4)
  v_mfma_f32_32x32x16_bf16 v[80:95], v[44:47], a[92:95], v[80:95]
  ds_read_b128 v[32:35], v7 offset:16384
  s_waitcnt lgkmcnt(4)
  s_waitcnt vmcnt(39)
  v_mfma_f32_32x32x16_bf16 v[48:63], v[16:19], a[96:99], v[48:63]
  ds_read_b128 v[36:39], v7 offset:17408
  s_waitcnt lgkmcnt(4)
  v_mfma_f32_32x32x16_bf16 v[64:79], v[20:23], a[96:99], v[64:79]
  ds_read_b128 v[40:43], v7 offset:18432
  s_waitcnt lgkmcnt(4)
  v_mfma_f32_32x32x16_bf16 v[80:95], v[24:27], a[96:99], v[80:95]
  ds_read_b128 v[44:47], v7 offset:19456
  s_waitcnt lgkmcnt(4)
  s_waitcnt vmcnt(38)
  v_mfma_f32_32x32x16_bf16 v[48:63], v[28:31], a[100:103], v[48:63]
  ds_read_b128 v[16:19], v7 offset:20480
  s_waitcnt lgkmcnt(4)
  v_mfma_f32_32x32x16_bf16 v[64:79], v[32:35], a[100:103], v[64:79]
  ds_read_b128 v[20:23], v7 offset:21504
  s_waitcnt lgkmcnt(4)
  v_mfma_f32_32x32x16_bf16 v[80:95], v[36:39], a[100:103], v[80:95]
  ds_read_b128 v[24:27], v7 offset:22528
  s_waitcnt lgkmcnt(4)
  s_waitcnt vmcnt(37)
  v_mfma_f32_32x32x16_bf16 v[48:63], v[40:43], a[104:107], v[48:63]
  ds_read_b128 v[28:31], v7 offset:23552
  s_waitcnt lgkmcnt(4)
  v_mfma_f32_32x32x16_bf16 v[64:79], v[44:47], a[104:107], v[64:79]
  ds_read_b128 v[32:35], v7 offset:24576
  s_waitcnt lgkmcnt(4)
  s_waitcnt vmcnt(32)
  s_barrier
  v_mfma_f32_32x32x16_bf16 v[80:95], v[16:19], a[104:107], v[80:95]
  ds_read_b128 v[36:39], v7 offset:25600
  s_waitcnt lgkmcnt(4)
  s_add_u32 m0, s21, 61440
  s_add_u32 s48, s23, 20480
  buffer_load_dwordx4 v1, s[4:7], s48 offen lds
  s_waitcnt vmcnt(32)
  v_mfma_f32_32x32x16_bf16 v[48:63], v[20:23], a[108:111], v[48:63]
  ds_read_b128 v[40:43], v7 offset:26624
  s_waitcnt lgkmcnt(4)
  buffer_load_dwordx4 v1, s[4:7], s48 offen offset:1024 lds
  v_mfma_f32_32x32x16_bf16 v[64:79], v[24:27], a[108:111], v[64:79]
  ds_read_b128 v[44:47], v7 offset:27648
  s_waitcnt lgkmcnt(4)
  buffer_load_dwordx4 v1, s[4:7], s48 offen offset:2048 lds
  v_mfma_f32_32x32x16_bf16 v[80:95], v[28:31], a[108:111], v[80:95]
  ds_read_b128 v[16:19], v7 offset:28672
  s_waitcnt lgkmcnt(4)
  buffer_load_dwordx4 v1, s[4:7], s48 offen offset:3072 lds
  s_add_u32 m0, s21, 65536
  s_add_u32 s48, s23, 24576
  s_waitcnt vmcnt(34)
  v_mfma_f32_32x32x16_bf16 v[48:63], v[32:35], a[112:115], v[48:63]
  ds_read_b128 v[20:23], v7 offset:29696
  s_waitcnt lgkmcnt(4)
  buffer_load_dwordx4 v1, s[4:7], s48 offen lds
  v_mfma_f32_32x32x16_bf16 v[64:79], v[36:39], a[112:115], v[64:79]
  ds_read_b128 v[24:27], v7 offset:30720
  s_waitcnt lgkmcnt(4)
  v_mfma_f32_32x32x16_bf16 v[80:95], v[40:43], a[112:115], v[80:95]
  ds_read_b128 v[28:31], v7 offset:31744
  s_waitcnt lgkmcnt(4)
  s_waitcnt vmcnt(34)
  v_mfma_f32_32x32x16_bf16 v[48:63], v[44:47], a[116:119], v[48:63]
  ds_read_b128 v[32:35], v7 offset:32768
  s_waitcnt lgkmcnt(4)
  v_mfma_f32_32x32x16_bf16 v[64:79], v[16:19], a[116:119], v[64:79]
  ds_read_b128 v[36:39], v7 offset:33792
  s_waitcnt lgkmcnt(4)
  v_mfma_f32_32x32x16_bf16 v[80:95], v[20:23], a[116:119], v[80:95]
  ds_read_b128 v[40:43], v7 offset:34816
  s_waitcnt lgkmcnt(4)
  s_waitcnt vmcnt(33)
  v_mfma_f32_32x32x16_bf16 v[48:63], v[24:27], a[120:123], v[48:63]
  ds_read_b128 v[44:47], v7 offset:35840
  s_waitcnt lgkmcnt(4)
  v_add_f32 v112, v112, v114
  v_add_f32 v113, v113, v115
  v_add_f32 v116, v116, v118
  v_add_f32 v117, v117, v119
  v_mfma_f32_32x32x16_bf16 v[64:79], v[28:31], a[120:123], v[64:79]
  ds_read_b128 v[16:19], v7 offset:36864
  s_waitcnt lgkmcnt(4)
  v_add_f32 v112, v112, v116
  v_add_f32 v113, v113, v117
  v_mov_b32 v114, v112
  v_mov_b32 v115, v113
  v_mfma_f32_32x32x16_bf16 v[80:95], v[32:35], a[120:123], v[80:95]
  ds_read_b128 v[20:23], v7 offset:37888
  s_waitcnt lgkmcnt(4)
  v_permlane32_swap_b32 v112, v114
  v_permlane32_swap_b32 v113, v115
  v_add_f32 v112, v112, v114
  v_add_f32 v113, v113, v115
  s_waitcnt vmcnt(28)
  v_mfma_f32_32x32x16_bf16 v[48:63], v[36:39], a[124:127], v[48:63]
  ds_read_b128 v[24:27], v7 offset:38912
  s_waitcnt lgkmcnt(4)
  v_mul_f32 v112, 0x3acccccd, v112
  v_mul_f32 v113, 0x3acccccd, v113
  v_fma_f32 v113, -v112, v112, v113
  v_max_f32 v113, 0, v113
  v_mfma_f32_32x32x16_bf16 v[64:79], v[40:43], a[124:127], v[64:79]
  ds_read_b128 v[28:31], v7 offset:39936
  s_waitcnt lgkmcnt(4)
  v_add_f32 v121, 0x3727c5ac, v113
  v_rsq_f32 v120, v121
  v_cvt_pk_bf16_f32 v114, -v112, -v112
  v_mfma_f32_32x32x16_bf16 v[80:95], v[44:47], a[124:127], v[80:95]
  ds_read_b128 v[32:35], v7 offset:40960
  s_waitcnt lgkmcnt(4)
  v_and_b32 v114, 0xffff0000, v114
  v_sub_f32 v114, -v112, v114
  v_cvt_pk_bf16_f32 v124, -v112, v114
  v_mov_b32 v125, v124
  s_waitcnt vmcnt(27)
  v_mfma_f32_32x32x16_bf16 v[48:63], v[16:19], a[128:131], v[48:63]
  ds_read_b128 v[36:39], v7 offset:41984
  s_waitcnt lgkmcnt(4)
  v_mov_b32 v126, v124
  v_mov_b32 v127, v124
  v_mul_f32 v122, 0x3fb8aa3b, v120
  v_mfma_f32_32x32x16_bf16 v[64:79], v[20:23], a[128:131], v[64:79]
  ds_read_b128 v[40:43], v7 offset:43008
  s_waitcnt lgkmcnt(4)
  v_mfma_f32_32x32x16_bf16 v[80:95], v[24:27], a[128:131], v[80:95]
  ds_read_b128 v[44:47], v7 offset:44032
  s_waitcnt lgkmcnt(4)
  s_waitcnt vmcnt(26)
  v_mfma_f32_32x32x16_bf16 v[48:63], v[28:31], a[132:135], v[48:63]
  ds_read_b128 v[16:19], v7 offset:45056
  s_waitcnt lgkmcnt(4)
  s_waitcnt vmcnt(21)
  s_barrier
  v_mfma_f32_32x32x16_bf16 v[64:79], v[32:35], a[132:135], v[64:79]
  ds_read_b128 v[20:23], v7 offset:46080
  s_waitcnt lgkmcnt(4)
  s_add_u32 m0, s21, 81920
  s_add_u32 s48, s23, 40960
  buffer_load_dwordx4 v1, s[4:7], s48 offen lds
  v_mfma_f32_32x32x16_bf16 v[80:95], v[36:39], a[132:135], v[80:95]
  ds_read_b128 v[24:27], v7 offset:47104
  s_waitcnt lgkmcnt(4)
  buffer_load_dwordx4 v1, s[4:7], s48 offen offset:1024 lds
  s_waitcnt vmcnt(22)
  v_mfma_f32_32x32x16_bf16 v[48:63], v[40:43], a[136:139], v[48:63]
  ds_read_b128 v[28:31], v7 offset:48128
  s_waitcnt lgkmcnt(4)
  buffer_load_dwordx4 v1, s[4:7], s48 offen offset:2048 lds
  v_mfma_f32_32x32x16_bf16 v[64:79], v[44:47], a[136:139], v[64:79]
  ds_read_b128 v[32:35], v7 offset:49152
  s_waitcnt lgkmcnt(4)
  buffer_load_dwordx4 v1, s[4:7], s48 offen offset:3072 lds
  s_add_u32 m0, s21, 86016
  s_add_u32 s48, s23, 45056
  v_mfma_f32_32x32x16_bf16 v[80:95], v[16:19], a[136:139], v[80:95]
  ds_read_b128 v[36:39], v7 offset:50176
  s_waitcnt lgkmcnt(4)
  buffer_load_dwordx4 v1, s[4:7], s48 offen lds
  s_waitcnt vmcnt(24)
  v_mfma_f32_32x32x16_bf16 v[48:63], v[20:23], a[140:143], v[48:63]
  ds_read_b128 v[40:43], v7 offset:51200
  s_waitcnt lgkmcnt(4)
  v_mfma_f32_32x32x16_bf16 v[64:79], v[24:27], a[140:143], v[64:79]
  ds_read_b128 v[44:47], v7 offset:52224
  s_waitcnt lgkmcnt(4)
  v_mfma_f32_32x32x16_bf16 v[80:95], v[28:31], a[140:143], v[80:95]
  ds_read_b128 v[16:19], v7 offset:53248
  s_waitcnt lgkmcnt(4)
  s_waitcnt vmcnt(23)
  v_mfma_f32_32x32x16_bf16 v[48:63], v[32:35], a[144:147], v[48:63]
  ds_read_b128 v[20:23], v7 offset:54272
  s_waitcnt lgkmcnt(4)
  v_mfma_f32_32x32x16_bf16 v[64:79], v[36:39], a[144:147], v[64:79]
  ds_read_b128 v[24:27], v7 offset:55296
  s_waitcnt lgkmcnt(4)
  v_mfma_f32_32x32x16_bf16 v[80:95], v[40:43], a[144:147], v[80:95]
  ds_read_b128 v[28:31], v7 offset:56320
  s_waitcnt lgkmcnt(4)
  s_waitcnt vmcnt(22)
  v_mfma_f32_32x32x16_bf16 v[48:63], v[44:47], a[148:151], v[48:63]
  ds_read_b128 v[32:35], v7 offset:57344
  s_waitcnt lgkmcnt(4)
  v_mfma_f32_32x32x16_bf16 v[64:79], v[16:19], a[148:151], v[64:79]
  ds_read_b128 v[36:39], v7 offset:58368
  s_waitcnt lgkmcnt(4)
  v_mfma_f32_32x32x16_bf16 v[80:95], v[20:23], a[148:151], v[80:95]
  ds_read_b128 v[40:43], v7 offset:59392
  s_waitcnt lgkmcnt(4)
  s_waitcnt vmcnt(21)
  v_mfma_f32_32x32x16_bf16 v[48:63], v[24:27], a[152:155], v[48:63]
  ds_read_b128 v[44:47], v7 offset:60416
  s_waitcnt lgkmcnt(4)
  v_mfma_f32_32x32x16_bf16 v[64:79], v[28:31], a[152:155], v[64:79]
  ds_read_b128 v[16:19], v1 offset:0
  s_waitcnt lgkmcnt(4)
  v_mfma_f32_32x32x16_bf16 v[80:95], v[32:35], a[152:155], v[80:95]
  ds_read_b128 v[20:23], v1 offset:1024
  s_waitcnt lgkmcnt(4)
  s_waitcnt vmcnt(20)
  v_mfma_f32_32x32x16_bf16 v[48:63], v[36:39], a[156:159], v[48:63]
  ds_read_b128 v[24:27], v1 offset:2048
  s_waitcnt lgkmcnt(4)
  v_mfma_f32_32x32x16_bf16 v[64:79], v[40:43], a[156:159], v[64:79]
  ds_read_b128 v[28:31], v1 offset:3072
  s_waitcnt lgkmcnt(4)
  v_mfma_f32_32x32x16_bf16 v[80:95], v[44:47], a[156:159], v[80:95]
  ds_read_b128 v[32:35], v1 offset:4096
  s_waitcnt lgkmcnt(4)
  s_waitcnt vmcnt(15)
  s_barrier
  v_mfma_f32_32x32x16_bf16 v[48:63], v[128:131], v[124:127], v[48:63]
  s_add_u32 m0, s21, 102400
  s_add_u32 s48, s23, 61440
  buffer_load_dwordx4 v1, s[4:7], s48 offen lds
  v_mfma_f32_32x32x16_bf16 v[64:79], v[132:135], v[124:127], v[64:79]
  buffer_load_dwordx4 v1, s[4:7], s48 offen offset:1024 lds
  v_mfma_f32_32x32x16_bf16 v[80:95], v[136:139], v[124:127], v[80:95]
  buffer_load_dwordx4 v1, s[4:7], s48 offen offset:2048 lds
  v_mfma_f32_32x32x16_bf16 v[96:111], v[16:19], a[0:3], 0
  ds_read_b128 v[36:39], v1 offset:5120
  s_waitcnt lgkmcnt(4)
  buffer_load_dwordx4 v1, s[4:7], s48 offen offset:3072 lds
  s_add_u32 m0, s21, 106496
  s_add_u32 s48, s23, 65536
  v_mfma_f32_32x32x16_bf16 v[96:111], v[20:23], a[4:7], v[96:111]
  ds_read_b128 v[40:43], v1 offset:6144
  s_waitcnt lgkmcnt(4)
  buffer_load_dwordx4 v1, s[4:7], s48 offen lds
  v_max3_f32 v112, v48, v49, v50
  v_min3_f32 v113, v48, v49, v50
  v_mfma_f32_32x32x16_bf16 v[96:111], v[24:27], a[8:11], v[96:111]
  ds_read_b128 v[44:47], v1 offset:7168
  s_waitcnt lgkmcnt(4)
  v_max3_f32 v112, v112, v51, v52
  v_min3_f32 v113, v113, v51, v52
  v_max3_f32 v112, v112, v53, v54
  v_min3_f32 v113, v113, v53, v54
  v_mfma_f32_32x32x16_bf16 v[96:111], v[28:31], a[12:15], v[96:111]
  ds_read_b128 v[16:19], v1 offset:8192
  s_waitcnt lgkmcnt(4)
  v_max3_f32 v112, v112, v55, v56
  v_min3_f32 v113, v113, v55, v56
  v_max3_f32 v112, v112, v57, v58
  v_min3_f32 v113, v113, v57, v58
  v_mfma_f32_32x32x16_bf16 v[96:111], v[32:35], a[16:19], v[96:111]
  ds_read_b128 v[20:23], v1 offset:9216
  s_waitcnt lgkmcnt(4)
  v_max3_f32 v112, v112, v59, v60
  v_min3_f32 v113, v113, v59, v60
  v_max3_f32 v112, v112, v61, v62
  v_min3_f32 v113, v113, v61, v62
  v_mfma_f32_32x32x16_bf16 v[96:111], v[36:39], a[20:23], v[96:111]
  ds_read_b128 v[24:27], v1 offset:10240
  s_waitcnt lgkmcnt(4)
  v_max3_f32 v112, v112, v63, v64
  v_min3_f32 v113, v113, v63, v64
  v_max3_f32 v112, v112, v65, v66
  v_min3_f32 v113, v113, v65, v66
  v_mfma_f32_32x32x16_bf16 v[96:111], v[40:43], a[24:27], v[96:111]
  ds_read_b128 v[28:31], v1 offset:11264
  s_waitcnt lgkmcnt(4)
  v_max_f32 v112, v112, v67
  v_min_f32 v113, v113, v67
  v_mul_f32 v114, v122, v112
  v_mul_f32 v115, v122, v113
  v_mfma_f32_32x32x16_bf16 v[96:111], v[44:47], a[28:31], v[96:111]
  ds_read_b128 v[32:35], v1 offset:12288
  s_waitcnt lgkmcnt(4)
  v_fma_f32 v144, v48, v122, -v114
  v_fma_f32 v164, -v48, v122, v115
  v_fma_f32 v145, v49, v122, -v114
  v_fma_f32 v165, -v49, v122, v115
  v_mfma_f32_32x32x16_bf16 v[96:111], v[16:19], a[32:35], v[96:111]
  ds_read_b128 v[36:39], v1 offset:13312
  s_waitcnt lgkmcnt(4)
  v_fma_f32 v146, v50, v122, -v114
  v_fma_f32 v166, -v50, v122, v115
  v_fma_f32 v147, v51, v122, -v114
  v_fma_f32 v167, -v51, v122, v115
  v_mfma_f32_32x32x16_bf16 v[96:111], v[20:23], a[36:39], v[96:111]
  ds_read_b128 v[40:43], v1 offset:14336
  s_waitcnt lgkmcnt(4)
  v_fma_f32 v148, v52, v122, -v114
  v_fma_f32 v168, -v52, v122, v115
  v_fma_f32 v149, v53, v122, -v114
  v_fma_f32 v169, -v53, v122, v115
  v_mfma_f32_32x32x16_bf16 v[96:111], v[24:27], a[40:43], v[96:111]
  ds_read_b128 v[44:47], v1 offset:15360
  s_waitcnt lgkmcnt(4)
  v_fma_f32 v150, v54, v122, -v114
  v_fma_f32 v170, -v54, v122, v115
  v_fma_f32 v151, v55, v122, -v114
  v_fma_f32 v171, -v55, v122, v115
  v_mfma_f32_32x32x16_bf16 v[96:111], v[28:31], a[44:47], v[96:111]
  ds_read_b128 v[16:19], v1 offset:16384
  s_waitcnt lgkmcnt(4)
  v_fma_f32 v152, v56, v122, -v114
  v_fma_f32 v172, -v56, v122, v115
  v_fma_f32 v153, v57, v122, -v114
  v_fma_f32 v173, -v57, v122, v115
  v_mfma_f32_32x32x16_bf16 v[96:111], v[32:35], a[48:51], v[96:111]
  ds_read_b128 v[20:23], v1 offset:17408
  s_waitcnt lgkmcnt(4)
  v_fma_f32 v154, v58, v122, -v114
  v_fma_f32 v174, -v58, v122, v115
  v_fma_f32 v155, v59, v122, -v114
  v_fma_f32 v175, -v59, v122, v115
  v_mfma_f32_32x32x16_bf16 v[96:111], v[36:39], a[52:55], v[96:111]
  ds_read_b128 v[24:27], v1 offset:18432
  s_waitcnt lgkmcnt(4)
  v_fma_f32 v156, v60, v122, -v114
  v_fma_f32 v176, -v60, v122, v115
  v_fma_f32 v157, v61, v122, -v114
  v_fma_f32 v177, -v61, v122, v115
  v_mfma_f32_32x32x16_bf16 v[96:111], v[40:43], a[56:59], v[96:111]
  ds_read_b128 v[28:31], v1 offset:19456
  s_waitcnt lgkmcnt(4)
  v_fma_f32 v158, v62, v122, -v114
  v_fma_f32 v178, -v62, v122, v115
  v_fma_f32 v159, v63, v122, -v114
  v_fma_f32 v179, -v63, v122, v115
  v_mfma_f32_32x32x16_bf16 v[96:111], v[44:47], a[60:63], v[96:111]
  s_waitcnt lgkmcnt(3)
  v_fma_f32 v160, v64, v122, -v114
  v_fma_f32 v180, -v64, v122, v115
  v_fma_f32 v161, v65, v122, -v114
  v_fma_f32 v181, -v65, v122, v115
  v_fma_f32 v162, v66, v122, -v114
  v_mfma_f32_32x32x16_bf16 v[96:111], v[16:19], a[64:67], v[96:111]
  s_waitcnt lgkmcnt(2)
  v_fma_f32 v182, -v66, v122, v115
  v_fma_f32 v163, v67, v122, -v114
  v_fma_f32 v183, -v67, v122, v115
  v_exp_f32 v144, v144
  v_mfma_f32_32x32x16_bf16 v[96:111], v[20:23], a[68:71], v[96:111]
  s_waitcnt lgkmcnt(1)
  v_exp_f32 v164, v164
  v_exp_f32 v145, v145
  v_mfma_f32_32x32x16_bf16 v[96:111], v[24:27], a[72:75], v[96:111]
  s_waitcnt lgkmcnt(0)
  v_exp_f32 v165, v165
  v_exp_f32 v146, v146
  v_mfma_f32_32x32x16_bf16 v[96:111], v[28:31], a[76:79], v[96:111]
  v_exp_f32 v166, v166
  v_exp_f32 v147, v147
  v_exp_f32 v167, v167
  v_exp_f32 v148, v148
  v_exp_f32 v168, v168
  v_exp_f32 v149, v149
  v_exp_f32 v169, v169
  v_exp_f32 v150, v150
  v_exp_f32 v170, v170
  v_exp_f32 v151, v151
  v_exp_f32 v171, v171
  v_exp_f32 v152, v152
  v_exp_f32 v172, v172
  v_exp_f32 v153, v153
  v_exp_f32 v173, v173
  v_exp_f32 v154, v154
  v_exp_f32 v174, v174
  v_exp_f32 v155, v155
  v_exp_f32 v175, v175
  v_exp_f32 v156, v156
  v_exp_f32 v176, v176
  v_exp_f32 v157, v157
  v_exp_f32 v177, v177
  v_exp_f32 v158, v158
  v_exp_f32 v178, v178
  v_exp_f32 v159, v159
  v_exp_f32 v179, v179
  v_exp_f32 v160, v160
  v_exp_f32 v180, v180
  v_exp_f32 v161, v161
  v_exp_f32 v181, v181
  v_exp_f32 v162, v162
  v_exp_f32 v182, v182
  v_exp_f32 v163, v163
  v_exp_f32 v183, v183
  v_add_f32 v116, v144, v145
  v_add_f32 v117, v164, v165
  v_add_f32 v116, v116, v146
  v_add_f32 v117, v117, v166
  v_add_f32 v116, v116, v147
  v_add_f32 v117, v117, v167
  v_add_f32 v116, v116, v148
  v_add_f32 v117, v117, v168
  v_add_f32 v116, v116, v149
  v_add_f32 v117, v117, v169
  v_add_f32 v116, v116, v150
  v_add_f32 v117, v117, v170
  v_add_f32 v116, v116, v151
  v_add_f32 v117, v117, v171
  v_add_f32 v116, v116, v152
  v_add_f32 v117, v117, v172
  v_add_f32 v116, v116, v153
  v_add_f32 v117, v117, v173
  v_add_f32 v116, v116, v154
  v_add_f32 v117, v117, v174
  v_add_f32 v116, v116, v155
  v_add_f32 v117, v117, v175
  v_add_f32 v116, v116, v156
  v_add_f32 v117, v117, v176
  v_add_f32 v116, v116, v157
  v_add_f32 v117, v117, v177
  v_add_f32 v116, v116, v158
  v_add_f32 v117, v117, v178
  v_add_f32 v116, v116, v159
  v_add_f32 v117, v117, v179
  v_add_f32 v116, v116, v160
  v_add_f32 v117, v117, v180
  v_add_f32 v116, v116, v161
  v_add_f32 v117, v117, v181
  v_add_f32 v116, v116, v162
  v_add_f32 v117, v117, v182
  v_add_f32 v116, v116, v163
  v_add_f32 v117, v117, v183
  v_rcp_f32 v116, v116
  v_rcp_f32 v117, v117
  v_mul_f32 v144, v144, v116
  v_mul_f32 v164, v164, v117
  v_mul_f32 v145, v145, v116
  v_mul_f32 v165, v165, v117
  v_mul_f32 v146, v146, v116
  v_mul_f32 v166, v166, v117
  v_mul_f32 v147, v147, v116
  v_mul_f32 v167, v167, v117
  v_mul_f32 v148, v148, v116
  v_mul_f32 v168, v168, v117
  v_mul_f32 v149, v149, v116
  v_mul_f32 v169, v169, v117
  v_mul_f32 v150, v150, v116
  v_mul_f32 v170, v170, v117
  v_mul_f32 v151, v151, v116
  v_mul_f32 v171, v171, v117
  v_mul_f32 v152, v152, v116
  v_mul_f32 v172, v172, v117
  v_mul_f32 v153, v153, v116
  v_mul_f32 v173, v173, v117
  v_mul_f32 v154, v154, v116
  v_mul_f32 v174, v174, v117
  v_mul_f32 v155, v155, v116
  v_mul_f32 v175, v175, v117
  v_mul_f32 v156, v156, v116
  v_mul_f32 v176, v176, v117
  v_mul_f32 v157, v157, v116
  v_mul_f32 v177, v177, v117
  v_mul_f32 v158, v158, v116
  v_mul_f32 v178, v178, v117
  v_mul_f32 v159, v159, v116
  v_mul_f32 v179, v179, v117
  v_mul_f32 v160, v160, v116
  v_mul_f32 v180, v180, v117
  v_mul_f32 v161, v161, v116
  v_mul_f32 v181, v181, v117
  v_mul_f32 v162, v162, v116
  v_mul_f32 v182, v182, v117
  v_mul_f32 v163, v163, v116
  v_mul_f32 v183, v183, v117
  v_cvt_pk_bf16_f32 v184, v144, v145
  v_cvt_pk_bf16_f32 v185, v146, v147
  v_cvt_pk_bf16_f32 v186, v148, v149
  v_cvt_pk_bf16_f32 v187, v150, v151
  v_cvt_pk_bf16_f32 v188, v152, v153
  v_cvt_pk_bf16_f32 v189, v154, v155
  v_cvt_pk_bf16_f32 v190, v156, v157
  v_cvt_pk_bf16_f32 v191, v158, v159
  v_cvt_pk_bf16_f32 v192, v160, v161
  v_cvt_pk_bf16_f32 v193, v162, v163
  v_cvt_pk_bf16_f32 v194, v164, v165
  v_cvt_pk_bf16_f32 v195, v166, v167
  v_cvt_pk_bf16_f32 v196, v168, v169
  v_cvt_pk_bf16_f32 v197, v170, v171
  v_cvt_pk_bf16_f32 v198, v172, v173
  v_cvt_pk_bf16_f32 v199, v174, v175
  v_cvt_pk_bf16_f32 v200, v176, v177
  v_cvt_pk_bf16_f32 v201, v178, v179
  v_cvt_pk_bf16_f32 v202, v180, v181
  v_cvt_pk_bf16_f32 v203, v182, v183
  v_mul_f32 v68, v68, v120
  v_mul_f32 v69, v69, v120
  v_mul_f32 v70, v70, v120
  v_mul_f32 v71, v71, v120
  v_mul_f32 v72, v72, v120
  v_mul_f32 v73, v73, v120
  v_mul_f32 v74, v74, v120
  v_mul_f32 v75, v75, v120
  v_mul_f32 v76, v76, v120
  v_mul_f32 v77, v77, v120
  v_mul_f32 v78, v78, v120
  v_mul_f32 v79, v79, v120
  v_mul_f32 v80, v80, v120
  v_mul_f32 v81, v81, v120
  v_mul_f32 v82, v82, v120
  v_mul_f32 v83, v83, v120
  v_mul_f32 v84, v84, v120
  v_mul_f32 v85, v85, v120
  v_mul_f32 v86, v86, v120
  v_mul_f32 v87, v87, v120
  v_cvt_pk_bf16_f32 v204, v68, v69
  v_cvt_pk_bf16_f32 v205, v70, v71
  v_cvt_pk_bf16_f32 v206, v72, v73
  v_cvt_pk_bf16_f32 v207, v74, v75
  v_cvt_pk_bf16_f32 v208, v76, v77
  v_cvt_pk_bf16_f32 v209, v78, v79
  v_cvt_pk_bf16_f32 v210, v80, v81
  v_cvt_pk_bf16_f32 v211, v82, v83
  v_cvt_pk_bf16_f32 v212, v84, v85
  v_cvt_pk_bf16_f32 v213, v86, v87
  v_mov_b32 v214, 0x3f80
  v_mov_b32 v215, 0
  ds_write_b128 v225, v[184:187] offset:0
  ds_write_b128 v225, v[188:191] offset:16
  ds_write_b128 v225, v[192:195] offset:32
  ds_write_b128 v225, v[196:199] offset:48
  ds_write_b128 v225, v[200:203] offset:64
  ds_write_b128 v225, v[204:207] offset:80
  ds_write_b128 v225, v[208:211] offset:96
  ds_write_b128 v225, v[212:215] offset:112
  s_waitcnt lgkmcnt(0)
  s_barrier
  ds_read_b64_tr_b16 v[16:17], v226 offset:0
  ds_read_b64_tr_b16 v[18:19], v226 offset:576
  ds_read_b64_tr_b16 v[20:21], v227 offset:0
  ds_read_b64_tr_b16 v[22:23], v227 offset:576
  ds_read_b64_tr_b16 v[24:25], v226 offset:2304
  ds_read_b64_tr_b16 v[26:27], v226 offset:2880
  ds_read_b64_tr_b16 v[28:29], v227 offset:2304
  ds_read_b64_tr_b16 v[30:31], v227 offset:2880
  ds_read_b64_tr_b16 v[32:33], v226 offset:4608
  ds_read_b64_tr_b16 v[34:35], v226 offset:5184
  ds_read_b64_tr_b16 v[36:37], v227 offset:4608
  ds_read_b64_tr_b16 v[38:39], v227 offset:5184
  ds_read_b64_tr_b16 v[40:41], v226 offset:6912
  ds_read_b64_tr_b16 v[42:43], v226 offset:7488
  ds_read_b64_tr_b16 v[44:45], v227 offset:6912
  ds_read_b64_tr_b16 v[46:47], v227 offset:7488
  s_waitcnt lgkmcnt(12)
  v_mfma_f32_32x32x16_bf16 v[48:63], v[16:19], v[20:23], 0
  ds_read_b64_tr_b16 v[16:17], v226 offset:9216
  ds_read_b64_tr_b16 v[18:19], v226 offset:9792
  ds_read_b64_tr_b16 v[20:21], v227 offset:9216
  ds_read_b64_tr_b16 v[22:23], v227 offset:9792
  s_waitcnt lgkmcnt(12)
  v_mfma_f32_32x32x16_bf16 v[48:63], v[24:27], v[28:31], v[48:63]
  ds_read_b64_tr_b16 v[24:25], v226 offset:11520
  ds_read_b64_tr_b16 v[26:27], v226 offset:12096
  ds_read_b64_tr_b16 v[28:29], v227 offset:11520
  ds_read_b64_tr_b16 v[30:31], v227 offset:12096
  s_waitcnt lgkmcnt(12)
  v_mfma_f32_32x32x16_bf16 v[48:63], v[32:35], v[36:39], v[48:63]
  ds_read_b64_tr_b16 v[32:33], v226 offset:13824
  ds_read_b64_tr_b16 v[34:35], v226 offset:14400
  ds_read_b64_tr_b16 v[36:37], v227 offset:13824
  ds_read_b64_tr_b16 v[38:39], v227 offset:14400
  s_waitcnt lgkmcnt(12)
  v_mfma_f32_32x32x16_bf16 v[48:63], v[40:43], v[44:47], v[48:63]
  ds_read_b64_tr_b16 v[40:41], v226 offset:16128
  ds_read_b64_tr_b16 v[42:43], v226 offset:16704
  ds_read_b64_tr_b16 v[44:45], v227 offset:16128
  ds_read_b64_tr_b16 v[46:47], v227 offset:16704
  s_waitcnt lgkmcnt(12)
  v_mfma_f32_32x32x16_bf16 v[48:63], v[16:19], v[20:23], v[48:63]
  s_waitcnt lgkmcnt(8)
  v_mfma_f32_32x32x16_bf16 v[48:63], v[24:27], v[28:31], v[48:63]
  s_waitcnt lgkmcnt(4)
  v_mfma_f32_32x32x16_bf16 v[48:63], v[32:35], v[36:39], v[48:63]
  s_waitcnt lgkmcnt(0)
  v_mfma_f32_32x32x16_bf16 v[48:63], v[40:43], v[44:47], v[48:63]
  s_nop 11
  v_cvt_pk_bf16_f32 v144, v48, v49
  v_cvt_pk_bf16_f32 v145, v50, v51
  v_cvt_pk_bf16_f32 v146, v52, v53
  v_cvt_pk_bf16_f32 v147, v54, v55
  v_cvt_pk_bf16_f32 v148, v56, v57
  v_cvt_pk_bf16_f32 v149, v58, v59
  s_lshl_b32 s26, s18, 4
  s_add_u32 s26, s26, s17
  s_lshl_b32 s26, s26, 12
  s_add_u32 s26, s26, s20
  s_add_u32 s26, s26, 0xdc0000
  buffer_store_dwordx4 v[144:147], v228, s[4:7], s26 offen sc1
  buffer_store_dwordx2 v[148:149], v229, s[4:7], s26 offen sc1
  s_mul_i32 s27, s18, 128
  s_add_u32 s27, s27, s3
  s_add_u32 s27, s27, 0x800
  s_add_u32 m0, s21, 0
  s_add_u32 s48, s23, 81920
  buffer_load_dwordx4 v1, s[4:7], s48 offen lds
  buffer_load_dwordx4 v1, s[4:7], s48 offen offset:1024 lds
  buffer_load_dwordx4 v1, s[4:7], s48 offen offset:2048 lds
  buffer_load_dwordx4 v1, s[4:7], s48 offen offset:3072 lds
  s_add_u32 m0, s21, 4096
  s_add_u32 s48, s23, 86016
  buffer_load_dwordx4 v1, s[4:7], s48 offen lds
  s_waitcnt vmcnt(5)
  s_barrier
  s_cmp_lg_u32 s16, 0
  s_cbranch_scc1 M_sig_7
  s_mov_b64 exec, 1
  buffer_atomic_add v5, v4, s[4:7], s27 offen sc1
  s_mov_b64 exec, -1
M_sig_7:
  s_cmp_lg_u32 s19, 0
  s_cbranch_scc1 M_xr_8
  s_mul_i32 s29, s45, 20480
  s_mul_i32 s31, s43, 160
  s_add_u32 s29, s29, s31
  buffer_load_dwordx4 v[240:243], v251, s[8:11], s29 offen
  buffer_load_dwordx4 v[244:247], v251, s[8:11], s29 offen offset:64
  buffer_load_dwordx2 v[248:249], v252, s[8:11], s29 offen
M_xr_8:
  ds_read_b128 v[32:35], v1 offset:20480
  ds_read_b128 v[36:39], v1 offset:21504
  ds_read_b128 v[40:43], v1 offset:22528
  ds_read_b128 v[44:47], v1 offset:23552
  ds_read_b128 v[16:19], v1 offset:24576
  s_waitcnt lgkmcnt(4)
  v_mfma_f32_32x32x16_bf16 v[96:111], v[32:35], a[80:83], v[96:111]
  ds_read_b128 v[20:23], v1 offset:25600
  s_waitcnt lgkmcnt(4)
  v_mov_b32 v164, 0
  v_mov_b32 v165, 0
  v_mov_b32 v166, 0
  v_mov_b32 v167, 0
  v_mfma_f32_32x32x16_bf16 v[96:111], v[36:39], a[84:87], v[96:111]
  ds_read_b128 v[24:27], v1 offset:26624
  s_waitcnt lgkmcnt(4)
  v_lshlrev_b32 v11, 4, v0
  v_add_u32 v11, 0x1e000, v11
  ds_write_b128 v11, v[164:167] offset:0
  ds_write_b128 v11, v[164:167] offset:4096
  v_mfma_f32_32x32x16_bf16 v[96:111], v[40:43], a[88:91], v[96:111]
  ds_read_b128 v[28:31], v1 offset:27648
  s_waitcnt lgkmcnt(6)
  ds_write_b128 v11, v[164:167] offset:8192
  v_mfma_f32_32x32x16_bf16 v[96:111], v[44:47], a[92:95], v[96:111]
  ds_read_b128 v[32:35], v1 offset:28672
  s_waitcnt lgkmcnt(7)
  v_mfma_f32_32x32x16_bf16 v[96:111], v[16:19], a[96:99], v[96:111]
  ds_read_b128 v[36:39], v1 offset:29696
  s_waitcnt lgkmcnt(7)
  v_mfma_f32_32x32x16_bf16 v[96:111], v[20:23], a[100:103], v[96:111]
  ds_read_b128 v[40:43], v1 offset:30720
  s_waitcnt lgkmcnt(7)
  v_mfma_f32_32x32x16_bf16 v[96:111], v[24:27], a[104:107], v[96:111]
  ds_read_b128 v[44:47], v1 offset:31744
  s_waitcnt lgkmcnt(5)
  v_mfma_f32_32x32x16_bf16 v[96:111], v[28:31], a[108:111], v[96:111]
  ds_read_b128 v[16:19], v1 offset:32768
  s_waitcnt lgkmcnt(4)
  v_mfma_f32_32x32x16_bf16 v[96:111], v[32:35], a[112:115], v[96:111]
  ds_read_b128 v[20:23], v1 offset:33792
  s_waitcnt lgkmcnt(4)
  v_mfma_f32_32x32x16_bf16 v[96:111], v[36:39], a[116:119], v[96:111]
  ds_read_b128 v[24:27], v1 offset:34816
  s_waitcnt lgkmcnt(4)
  v_mfma_f32_32x32x16_bf16 v[96:111], v[40:43], a[120:123], v[96:111]
  ds_read_b128 v[28:31], v1 offset:35840
  s_waitcnt lgkmcnt(4)
  v_mfma_f32_32x32x16_bf16 v[96:111], v[44:47], a[124:127], v[96:111]
  ds_read_b128 v[32:35], v1 offset:36864
  s_waitcnt lgkmcnt(4)
  v_mfma_f32_32x32x16_bf16 v[96:111], v[16:19], a[128:131], v[96:111]
  ds_read_b128 v[36:39], v1 offset:37888
  s_waitcnt lgkmcnt(4)
  v_mfma_f32_32x32x16_bf16 v[96:111], v[20:23], a[132:135], v[96:111]
  ds_read_b128 v[40:43], v1 offset:38912
  s_waitcnt lgkmcnt(4)
  v_mfma_f32_32x32x16_bf16 v[96:111], v[24:27], a[136:139], v[96:111]
  ds_read_b128 v[44:47], v1 offset:39936
  s_waitcnt lgkmcnt(4)
  v_mfma_f32_32x32x16_bf16 v[96:111], v[28:31], a[140:143], v[96:111]
  s_waitcnt lgkmcnt(3)
  v_mfma_f32_32x32x16_bf16 v[96:111], v[32:35], a[144:147], v[96:111]
  s_waitcnt lgkmcnt(2)
  v_mfma_f32_32x32x16_bf16 v[96:111], v[36:39], a[148:151], v[96:111]
  s_waitcnt lgkmcnt(1)
  v_mfma_f32_32x32x16_bf16 v[96:111], v[40:43], a[152:155], v[96:111]
  s_waitcnt lgkmcnt(0)
  v_mfma_f32_32x32x16_bf16 v[96:111], v[44:47], a[156:159], v[96:111]
  v_mfma_f32_32x32x16_bf16 v[96:111], v[140:143], v[124:127], v[96:111]
  v_max3_f32 v112, v88, v89, v90
  v_min3_f32 v113, v88, v89, v90
  v_max3_f32 v112, v112, v91, v92
  v_min3_f32 v113, v113, v91, v92
  v_max3_f32 v112, v112, v93, v94
  v_min3_f32 v113, v113, v93, v94
  s_nop 5
  v_max3_f32 v112, v112, v95, v96
  v_min3_f32 v113, v113, v95, v96
  v_max3_f32 v112, v112, v97, v98
  v_min3_f32 v113, v113, v97, v98
  v_max3_f32 v112, v112, v99, v100
  v_min3_f32 v113, v113, v99, v100
  v_max3_f32 v112, v112, v101, v102
  v_min3_f32 v113, v113, v101, v102
  v_max3_f32 v112, v112, v103, v104
  v_min3_f32 v113, v113, v103, v104
  v_max3_f32 v112, v112, v105, v106
  v_min3_f32 v113, v113, v105, v106
  v_max_f32 v112, v112, v107
  v_min_f32 v113, v113, v107
  v_mul_f32 v114, v122, v112
  v_mul_f32 v115, v122, v113
  v_fma_f32 v144, v88, v122, -v114
  v_fma_f32 v164, -v88, v122, v115
  v_fma_f32 v145, v89, v122, -v114
  v_fma_f32 v165, -v89, v122, v115
  v_fma_f32 v146, v90, v122, -v114
  v_fma_f32 v166, -v90, v122, v115
  v_fma_f32 v147, v91, v122, -v114
  v_fma_f32 v167, -v91, v122, v115
  v_fma_f32 v148, v92, v122, -v114
  v_fma_f32 v168, -v92, v122, v115
  v_fma_f32 v149, v93, v122, -v114
  v_fma_f32 v169, -v93, v122, v115
  v_fma_f32 v150, v94, v122, -v114
  v_fma_f32 v170, -v94, v122, v115
  v_fma_f32 v151, v95, v122, -v114
  v_fma_f32 v171, -v95, v122, v115
  v_fma_f32 v152, v96, v122, -v114
  v_fma_f32 v172, -v96, v122, v115
  v_fma_f32 v153, v97, v122, -v114
  v_fma_f32 v173, -v97, v122, v115
  v_fma_f32 v154, v98, v122, -v114
  v_fma_f32 v174, -v98, v122, v115
  v_fma_f32 v155, v99, v122, -v114
  v_fma_f32 v175, -v99, v122, v115
  v_fma_f32 v156, v100, v122, -v114
  v_fma_f32 v176, -v100, v122, v115
  v_fma_f32 v157, v101, v122, -v114
  v_fma_f32 v177, -v101, v122, v115
  v_fma_f32 v158, v102, v122, -v114
  v_fma_f32 v178, -v102, v122, v115
  v_fma_f32 v159, v103, v122, -v114
  v_fma_f32 v179, -v103, v122, v115
  v_fma_f32 v160, v104, v122, -v114
  v_fma_f32 v180, -v104, v122, v115
  v_fma_f32 v161, v105, v122, -v114
  v_fma_f32 v181, -v105, v122, v115
  v_fma_f32 v162, v106, v122, -v114
  v_fma_f32 v182, -v106, v122, v115
  v_fma_f32 v163, v107, v122, -v114
  v_fma_f32 v183, -v107, v122, v115
  v_exp_f32 v144, v144
  v_exp_f32 v164, v164
  v_exp_f32 v145, v145
  v_exp_f32 v165, v165
  v_exp_f32 v146, v146
  v_exp_f32 v166, v166
  v_exp_f32 v147, v147
  v_exp_f32 v167, v167
  v_exp_f32 v148, v148
  v_exp_f32 v168, v168
  v_exp_f32 v149, v149
  v_exp_f32 v169, v169
  v_exp_f32 v150, v150
  v_exp_f32 v170, v170
  v_exp_f32 v151, v151
  v_exp_f32 v171, v171
  v_exp_f32 v152, v152
  v_exp_f32 v172, v172
  v_exp_f32 v153, v153
  v_exp_f32 v173, v173
  v_exp_f32 v154, v154
  v_exp_f32 v174, v174
  v_exp_f32 v155, v155
  v_exp_f32 v175, v175
  v_exp_f32 v156, v156
  v_exp_f32 v176, v176
  v_exp_f32 v157, v157
  v_exp_f32 v177, v177
  v_exp_f32 v158, v158
  v_exp_f32 v178, v178
  v_exp_f32 v159, v159
  v_exp_f32 v179, v179
  v_exp_f32 v160, v160
  v_exp_f32 v180, v180
  v_exp_f32 v161, v161
  v_exp_f32 v181, v181
  v_exp_f32 v162, v162
  v_exp_f32 v182, v182
  v_exp_f32 v163, v163
  v_exp_f32 v183, v183
  v_add_f32 v116, v144, v145
  v_add_f32 v117, v164, v165
  v_add_f32 v116, v116, v146
  v_add_f32 v117, v117, v166
  v_add_f32 v116, v116, v147
  v_add_f32 v117, v117, v167
  v_add_f32 v116, v116, v148
  v_add_f32 v117, v117, v168
  v_add_f32 v116, v116, v149
  v_add_f32 v117, v117, v169
  v_add_f32 v116, v116, v150
  v_add_f32 v117, v117, v170
  v_add_f32 v116, v116, v151
  v_add_f32 v117, v117, v171
  v_add_f32 v116, v116, v152
  v_add_f32 v117, v117, v172
  v_add_f32 v116, v116, v153
  v_add_f32 v117, v117, v173
  v_add_f32 v116, v116, v154
  v_add_f32 v117, v117, v174
  v_add_f32 v116, v116, v155
  v_add_f32 v117, v117, v175
  v_add_f32 v116, v116, v156
  v_add_f32 v117, v117, v176
  v_add_f32 v116, v116, v157
  v_add_f32 v117, v117, v177
  v_add_f32 v116, v116, v158
  v_add_f32 v117, v117, v178
  v_add_f32 v116, v116, v159
  v_add_f32 v117, v117, v179
  v_add_f32 v116, v116, v160
  v_add_f32 v117, v117, v180
  v_add_f32 v116, v116, v161
  v_add_f32 v117, v117, v181
  v_add_f32 v116, v116, v162
  v_add_f32 v117, v117, v182
  v_add_f32 v116, v116, v163
  v_add_f32 v117, v117, v183
  v_rcp_f32 v116, v116
  v_rcp_f32 v117, v117
  v_mul_f32 v144, v144, v116
  v_mul_f32 v164, v164, v117
  v_mul_f32 v145, v145, v116
  v_mul_f32 v165, v165, v117
  v_mul_f32 v146, v146, v116
  v_mul_f32 v166, v166, v117
  v_mul_f32 v147, v147, v116
  v_mul_f32 v167, v167, v117
  v_mul_f32 v148, v148, v116
  v_mul_f32 v168, v168, v117
  v_mul_f32 v149, v149, v116
  v_mul_f32 v169, v169, v117
  v_mul_f32 v150, v150, v116
  v_mul_f32 v170, v170, v117
  v_mul_f32 v151, v151, v116
  v_mul_f32 v171, v171, v117
  v_mul_f32 v152, v152, v116
  v_mul_f32 v172, v172, v117
  v_mul_f32 v153, v153, v116
  v_mul_f32 v173, v173, v117
  v_mul_f32 v154, v154, v116
  v_mul_f32 v174, v174, v117
  v_mul_f32 v155, v155, v116
  v_mul_f32 v175, v175, v117
  v_mul_f32 v156, v156, v116
  v_mul_f32 v176, v176, v117
  v_mul_f32 v157, v157, v116
  v_mul_f32 v177, v177, v117
  v_mul_f32 v158, v158, v116
  v_mul_f32 v178, v178, v117
  v_mul_f32 v159, v159, v116
  v_mul_f32 v179, v179, v117
  v_mul_f32 v160, v160, v116
  v_mul_f32 v180, v180, v117
  v_mul_f32 v161, v161, v116
  v_mul_f32 v181, v181, v117
  v_mul_f32 v162, v162, v116
  v_mul_f32 v182, v182, v117
  v_mul_f32 v163, v163, v116
  v_mul_f32 v183, v183, v117
  v_cvt_pk_bf16_f32 v184, v144, v145
  v_cvt_pk_bf16_f32 v185, v146, v147
  v_cvt_pk_bf16_f32 v186, v152, v153
  v_cvt_pk_bf16_f32 v187, v154, v155
  v_cvt_pk_bf16_f32 v188, v148, v149
  v_cvt_pk_bf16_f32 v189, v150, v151
  v_cvt_pk_bf16_f32 v190, v156, v157
  v_cvt_pk_bf16_f32 v191, v158, v159
  v_cvt_pk_bf16_f32 v192, v164, v165
  v_cvt_pk_bf16_f32 v193, v166, v167
  v_cvt_pk_bf16_f32 v194, v172, v173
  v_cvt_pk_bf16_f32 v195, v174, v175
  v_cvt_pk_bf16_f32 v196, v168, v169
  v_cvt_pk_bf16_f32 v197, v170, v171
  v_cvt_pk_bf16_f32 v198, v176, v177
  v_cvt_pk_bf16_f32 v199, v178, v179
  v_cvt_pk_bf16_f32 v200, v160, v161
  v_cvt_pk_bf16_f32 v201, v162, v163
  v_cvt_pk_bf16_f32 v202, v180, v181
  v_cvt_pk_bf16_f32 v203, v182, v183
  s_cmp_lg_u32 s16, 0
  s_cbranch_scc1 M_got_10
  s_cmp_lg_u32 s40, 0
  s_cbranch_scc1 M_got_10
  s_mov_b32 s41, 0
M_poll_9:
  buffer_load_dword v6, v4, s[4:7], s27 offen sc1
  s_waitcnt vmcnt(0)
  v_cmp_gt_u32 vcc, 16, v6
  s_nop 4
  s_cbranch_vccz M_got_10
  s_add_u32 s41, s41, 1
  s_cmp_lt_u32 s41, 40000
  s_cbranch_scc1 M_poll_9
  s_mov_b32 s40, 1
M_got_10:
  s_barrier
  s_lshl_b32 s26, s18, 16
  s_add_u32 s26, s26, s20
  s_add_u32 s26, s26, 0xdc0000
  buffer_load_dwordx4 v[112:115], v230, s[4:7], s26 offen sc1
  s_add_u32 s26, s26, 4096
  buffer_load_dwordx4 v[116:119], v230, s[4:7], s26 offen sc1
  s_add_u32 s26, s26, 4096
  buffer_load_dwordx4 v[120:123], v230, s[4:7], s26 offen sc1
  s_add_u32 s26, s26, 4096
  buffer_load_dwordx4 v[124:127], v230, s[4:7], s26 offen sc1
  s_add_u32 s26, s26, 4096
  buffer_load_dwordx4 v[128:131], v230, s[4:7], s26 offen sc1
  s_add_u32 s26, s26, 4096
  buffer_load_dwordx4 v[132:135], v230, s[4:7], s26 offen sc1
  s_add_u32 s26, s26, 4096
  buffer_load_dwordx4 v[136:139], v230, s[4:7], s26 offen sc1
  s_add_u32 s26, s26, 4096
  buffer_load_dwordx4 v[140:143], v230, s[4:7], s26 offen sc1
  s_add_u32 s26, s26, 4096
  buffer_load_dwordx4 v[144:147], v230, s[4:7], s26 offen sc1
  s_add_u32 s26, s26, 4096
  buffer_load_dwordx4 v[148:151], v230, s[4:7], s26 offen sc1
  s_add_u32 s26, s26, 4096
  buffer_load_dwordx4 v[152:155], v230, s[4:7], s26 offen sc1
  s_add_u32 s26, s26, 4096
  buffer_load_dwordx4 v[156:159], v230, s[4:7], s26 offen sc1
  s_add_u32 s26, s26, 4096
  buffer_load_dwordx4 v[160:163], v230, s[4:7], s26 offen sc1
  s_add_u32 s26, s26, 4096
  buffer_load_dwordx4 v[164:167], v230, s[4:7], s26 offen sc1
  s_add_u32 s26, s26, 4096
  buffer_load_dwordx4 v[168:171], v230, s[4:7], s26 offen sc1
  s_add_u32 s26, s26, 4096
  buffer_load_dwordx4 v[172:175], v230, s[4:7], s26 offen sc1
  v_mov_b32 v12, 0x00003f80
  v_mov_b32 v13, 0x3f800000
  v_mov_b32 v176, 0
  v_mov_b32 v177, 0
  v_mov_b32 v178, 0
  v_mov_b32 v179, 0
  v_mov_b32 v180, 0
  v_mov_b32 v181, 0
  v_mov_b32 v182, 0
  v_mov_b32 v183, 0
  s_waitcnt vmcnt(15)
  v_dot2c_f32_bf16 v176, v112, v12
  v_dot2c_f32_bf16 v177, v112, v13
  v_dot2c_f32_bf16 v178, v113, v12
  v_dot2c_f32_bf16 v179, v113, v13
  v_dot2c_f32_bf16 v180, v114, v12
  v_dot2c_f32_bf16 v181, v114, v13
  v_dot2c_f32_bf16 v182, v115, v12
  v_dot2c_f32_bf16 v183, v115, v13
  s_waitcnt vmcnt(14)
  v_dot2c_f32_bf16 v176, v116, v12
  v_dot2c_f32_bf16 v177, v116, v13
  v_dot2c_f32_bf16 v178, v117, v12
  v_dot2c_f32_bf16 v179, v117, v13
  v_dot2c_f32_bf16 v180, v118, v12
  v_dot2c_f32_bf16 v181, v118, v13
  v_dot2c_f32_bf16 v182, v119, v12
  v_dot2c_f32_bf16 v183, v119, v13
  s_waitcnt vmcnt(13)
  v_dot2c_f32_bf16 v176, v120, v12
  v_dot2c_f32_bf16 v177, v120, v13
  v_dot2c_f32_bf16 v178, v121, v12
  v_dot2c_f32_bf16 v179, v121, v13
  v_dot2c_f32_bf16 v180, v122, v12
  v_dot2c_f32_bf16 v181, v122, v13
  v_dot2c_f32_bf16 v182, v123, v12
  v_dot2c_f32_bf16 v183, v123, v13
  s_waitcnt vmcnt(12)
  v_dot2c_f32_bf16 v176, v124, v12
  v_dot2c_f32_bf16 v177, v124, v13
  v_dot2c_f32_bf16 v178, v125, v12
  v_dot2c_f32_bf16 v179, v125, v13
  v_dot2c_f32_bf16 v180, v126, v12
  v_dot2c_f32_bf16 v181, v126, v13
  v_dot2c_f32_bf16 v182, v127, v12
  v_dot2c_f32_bf16 v183, v127, v13
  s_waitcnt vmcnt(11)
  v_dot2c_f32_bf16 v176, v128, v12
  v_dot2c_f32_bf16 v177, v128, v13
  v_dot2c_f32_bf16 v178, v129, v12
  v_dot2c_f32_bf16 v179, v129, v13
  v_dot2c_f32_bf16 v180, v130, v12
  v_dot2c_f32_bf16 v181, v130, v13
  v_dot2c_f32_bf16 v182, v131, v12
  v_dot2c_f32_bf16 v183, v131, v13
  s_waitcnt vmcnt(10)
  v_dot2c_f32_bf16 v176, v132, v12
  v_dot2c_f32_bf16 v177, v132, v13
  v_dot2c_f32_bf16 v178, v133, v12
  v_dot2c_f32_bf16 v179, v133, v13
  v_dot2c_f32_bf16 v180, v134, v12
  v_dot2c_f32_bf16 v181, v134, v13
  v_dot2c_f32_bf16 v182, v135, v12
  v_dot2c_f32_bf16 v183, v135, v13
  s_waitcnt vmcnt(9)
  v_dot2c_f32_bf16 v176, v136, v12
  v_dot2c_f32_bf16 v177, v136, v13
  v_dot2c_f32_bf16 v178, v137, v12
  v_dot2c_f32_bf16 v179, v137, v13
  v_dot2c_f32_bf16 v180, v138, v12
  v_dot2c_f32_bf16 v181, v138, v13
  v_dot2c_f32_bf16 v182, v139, v12
  v_dot2c_f32_bf16 v183, v139, v13
  s_waitcnt vmcnt(8)
  v_dot2c_f32_bf16 v176, v140, v12
  v_dot2c_f32_bf16 v177, v140, v13
  v_dot2c_f32_bf16 v178, v141, v12
  v_dot2c_f32_bf16 v179, v141, v13
  v_dot2c_f32_bf16 v180, v142, v12
  v_dot2c_f32_bf16 v181, v142, v13
  v_dot2c_f32_bf16 v182, v143, v12
  v_dot2c_f32_bf16 v183, v143, v13
  s_waitcnt vmcnt(7)
  v_dot2c_f32_bf16 v176, v144, v12
  v_dot2c_f32_bf16 v177, v144, v13
  v_dot2c_f32_bf16 v178, v145, v12
  v_dot2c_f32_bf16 v179, v145, v13
  v_dot2c_f32_bf16 v180, v146, v12
  v_dot2c_f32_bf16 v181, v146, v13
  v_dot2c_f32_bf16 v182, v147, v12
  v_dot2c_f32_bf16 v183, v147, v13
  s_waitcnt vmcnt(6)
  v_dot2c_f32_bf16 v176, v148, v12
  v_dot2c_f32_bf16 v177, v148, v13
  v_dot2c_f32_bf16 v178, v149, v12
  v_dot2c_f32_bf16 v179, v149, v13
  v_dot2c_f32_bf16 v180, v150, v12
  v_dot2c_f32_bf16 v181, v150, v13
  v_dot2c_f32_bf16 v182, v151, v12
  v_dot2c_f32_bf16 v183, v151, v13
  s_waitcnt vmcnt(5)
  v_dot2c_f32_bf16 v176, v152, v12
  v_dot2c_f32_bf16 v177, v152, v13
  v_dot2c_f32_bf16 v178, v153, v12
  v_dot2c_f32_bf16 v179, v153, v13
  v_dot2c_f32_bf16 v180, v154, v12
  v_dot2c_f32_bf16 v181, v154, v13
  v_dot2c_f32_bf16 v182, v155, v12
  v_dot2c_f32_bf16 v183, v155, v13
  s_waitcnt vmcnt(4)
  v_dot2c_f32_bf16 v176, v156, v12
  v_dot2c_f32_bf16 v177, v156, v13
  v_dot2c_f32_bf16 v178, v157, v12
  v_dot2c_f32_bf16 v179, v157, v13
  v_dot2c_f32_bf16 v180, v158, v12
  v_dot2c_f32_bf16 v181, v158, v13
  v_dot2c_f32_bf16 v182, v159, v12
  v_dot2c_f32_bf16 v183, v159, v13
  s_waitcnt vmcnt(3)
  v_dot2c_f32_bf16 v176, v160, v12
  v_dot2c_f32_bf16 v177, v160, v13
  v_dot2c_f32_bf16 v178, v161, v12
  v_dot2c_f32_bf16 v179, v161, v13
  v_dot2c_f32_bf16 v180, v162, v12
  v_dot2c_f32_bf16 v181, v162, v13
  v_dot2c_f32_bf16 v182, v163, v12
  v_dot2c_f32_bf16 v183, v163, v13
  s_waitcnt vmcnt(2)
  v_dot2c_f32_bf16 v176, v164, v12
  v_dot2c_f32_bf16 v177, v164, v13
  v_dot2c_f32_bf16 v178, v165, v12
  v_dot2c_f32_bf16 v179, v165, v13
  v_dot2c_f32_bf16 v180, v166, v12
  v_dot2c_f32_bf16 v181, v166, v13
  v_dot2c_f32_bf16 v182, v167, v12
  v_dot2c_f32_bf16 v183, v167, v13
  s_waitcnt vmcnt(1)
  v_dot2c_f32_bf16 v176, v168, v12
  v_dot2c_f32_bf16 v177, v168, v13
  v_dot2c_f32_bf16 v178, v169, v12
  v_dot2c_f32_bf16 v179, v169, v13
  v_dot2c_f32_bf16 v180, v170, v12
  v_dot2c_f32_bf16 v181, v170, v13
  v_dot2c_f32_bf16 v182, v171, v12
  v_dot2c_f32_bf16 v183, v171, v13
  s_waitcnt vmcnt(0)
  v_dot2c_f32_bf16 v176, v172, v12
  v_dot2c_f32_bf16 v177, v172, v13
  v_dot2c_f32_bf16 v178, v173, v12
  v_dot2c_f32_bf16 v179, v173, v13
  v_dot2c_f32_bf16 v180, v174, v12
  v_dot2c_f32_bf16 v181, v174, v13
  v_dot2c_f32_bf16 v182, v175, v12
  v_dot2c_f32_bf16 v183, v175, v13
  v_cvt_pk_bf16_f32 v204, v176, v177
  v_cvt_pk_bf16_f32 v205, v178, v179
  v_cvt_pk_bf16_f32 v206, v180, v181
  v_cvt_pk_bf16_f32 v207, v182, v183
  ds_write_b128 v231, v[204:207]
  ds_write_b64 v221, v[204:205]
  s_waitcnt lgkmcnt(0)
  s_barrier
  v_add_u32 v11, 0x1e000, v1
  ds_read_b128 v[16:19], v11 offset:0
  ds_read_b128 v[20:23], v11 offset:1024
  ds_read_b128 v[24:27], v11 offset:2048
  ds_read_b128 v[28:31], v11 offset:3072
  ds_read_b128 v[32:35], v11 offset:4096
  ds_read_b128 v[36:39], v11 offset:5120
  ds_read_b128 v[40:43], v11 offset:6144
  ds_read_b128 v[44:47], v11 offset:7168
  s_waitcnt lgkmcnt(7)
  v_mfma_f32_32x32x16_bf16 v[48:63], v[16:19], v[184:187], 0
  ds_read_b128 v[16:19], v11 offset:8192
  s_waitcnt lgkmcnt(7)
  v_mfma_f32_32x32x16_bf16 v[48:63], v[20:23], v[188:191], v[48:63]
  ds_read_b128 v[20:23], v11 offset:9216
  s_waitcnt lgkmcnt(7)
  v_mfma_f32_32x32x16_bf16 v[48:63], v[24:27], v[192:195], v[48:63]
  s_waitcnt lgkmcnt(6)
  v_mfma_f32_32x32x16_bf16 v[48:63], v[28:31], v[196:199], v[48:63]
  s_waitcnt lgkmcnt(5)
  v_mfma_f32_32x32x16_bf16 v[48:63], v[32:35], v[200:203], v[48:63]
  s_waitcnt lgkmcnt(4)
  v_mfma_f32_32x32x16_bf16 v[64:79], v[36:39], v[184:187], 0
  s_waitcnt lgkmcnt(3)
  v_mfma_f32_32x32x16_bf16 v[64:79], v[40:43], v[188:191], v[64:79]
  s_waitcnt lgkmcnt(2)
  v_mfma_f32_32x32x16_bf16 v[64:79], v[44:47], v[192:195], v[64:79]
  s_waitcnt lgkmcnt(1)
  v_mfma_f32_32x32x16_bf16 v[64:79], v[16:19], v[196:199], v[64:79]
  s_waitcnt lgkmcnt(0)
  v_mfma_f32_32x32x16_bf16 v[64:79], v[20:23], v[200:203], v[64:79]
  s_nop 11
  v_add_f32 v12, 0x358637bd, v68
  v_rcp_f32 v12, v12
  s_nop 0
  v_mul_f32 v48, v48, v12
  v_mul_f32 v49, v49, v12
  v_mul_f32 v50, v50, v12
  v_mul_f32 v51, v51, v12
  v_mul_f32 v52, v52, v12
  v_mul_f32 v53, v53, v12
  v_mul_f32 v54, v54, v12
  v_mul_f32 v55, v55, v12
  v_mul_f32 v56, v56, v12
  v_mul_f32 v57, v57, v12
  v_mul_f32 v58, v58, v12
  v_mul_f32 v59, v59, v12
  v_mul_f32 v60, v60, v12
  v_mul_f32 v61, v61, v12
  v_mul_f32 v62, v62, v12
  v_mul_f32 v63, v63, v12
  v_mul_f32 v64, v64, v12
  v_mul_f32 v65, v65, v12
  v_mul_f32 v66, v66, v12
  v_mul_f32 v67, v67, v12
  v_cvt_pk_bf16_f32 v208, v48, v49
  v_cvt_pk_bf16_f32 v209, v50, v51
  v_cvt_pk_bf16_f32 v210, v52, v53
  v_cvt_pk_bf16_f32 v211, v54, v55
  v_cvt_pk_bf16_f32 v212, v56, v57
  v_cvt_pk_bf16_f32 v213, v58, v59
  v_cvt_pk_bf16_f32 v214, v60, v61
  v_cvt_pk_bf16_f32 v215, v62, v63
  v_cvt_pk_bf16_f32 v216, v64, v65
  v_cvt_pk_bf16_f32 v217, v66, v67
  s_lshl_b32 s26, s17, 3
  s_lshl_b32 s27, s16, 1
  s_add_u32 s26, s26, s27
  s_mul_i32 s26, s26, 20480
  s_add_u32 s26, s26, s20
  s_add_u32 s26, s26, 0x2a0000
  buffer_store_dwordx4 v[208:211], v232, s[4:7], s26 offen sc1
  buffer_store_dwordx4 v[212:215], v233, s[4:7], s26 offen sc1
  buffer_store_dwordx2 v[216:217], v234, s[4:7], s26 offen sc1
  s_mul_i32 s27, s17, 128
  s_add_u32 s27, s27, s3
  s_add_u32 s27, s27, 0x1000
  s_add_u32 m0, s21, 20480
  s_add_u32 s48, s24, 0
  buffer_load_dwordx4 v1, s[4:7], s48 offen lds
  buffer_load_dwordx4 v1, s[4:7], s48 offen offset:1024 lds
  buffer_load_dwordx4 v1, s[4:7], s48 offen offset:2048 lds
  buffer_load_dwordx4 v1, s[4:7], s48 offen offset:3072 lds
  s_add_u32 m0, s21, 24576
  s_add_u32 s48, s24, 4096
  buffer_load_dwordx4 v1, s[4:7], s48 offen lds
  s_waitcnt vmcnt(5)
  s_barrier
  s_cmp_lg_u32 s16, 0
  s_cbranch_scc1 M_sig_11
  s_mov_b64 exec, 1
  buffer_atomic_add v5, v4, s[4:7], s27 offen sc1
  s_mov_b64 exec, -1
M_sig_11:
  s_mul_i32 s26, s17, 128
  s_add_u32 s26, s26, s3
  s_add_u32 s26, s26, 0x1000
  s_mul_i32 s50, s45, 20
  s_mul_i32 s27, s47, 10
  s_add_u32 s50, s50, s27
  s_lshl_b32 s50, s50, 10
  s_add_u32 s50, s50, s20
  s_add_u32 s50, s50, 0x2a0000
  s_mul_i32 s51, s46, 20
  s_mul_i32 s27, s47, 10
  s_add_u32 s51, s51, s27
  s_lshl_b32 s51, s51, 10
  s_add_u32 s51, s51, s20
  s_add_u32 s51, s51, 0x2a0000
  s_cmp_lg_u32 s16, 0
  s_cbranch_scc1 M_got_13
  s_cmp_lg_u32 s40, 0
  s_cbranch_scc1 M_got_13
  s_mov_b32 s41, 0
M_poll_12:
  buffer_load_dword v6, v4, s[4:7], s26 offen sc1
  s_waitcnt vmcnt(0)
  v_cmp_gt_u32 vcc, 16, v6
  s_nop 4
  s_cbranch_vccz M_got_13
  s_add_u32 s41, s41, 1
  s_cmp_lt_u32 s41, 40000
  s_cbranch_scc1 M_poll_12
  s_mov_b32 s40, 1
M_got_13:
  s_barrier
  s_add_u32 s52, s50, 0
  buffer_load_dwordx4 a[0:3], v1, s[4:7], s52 offen offset:0 sc1
  s_add_u32 s53, s51, 0
  buffer_load_dwordx4 a[4:7], v1, s[4:7], s53 offen offset:0 sc1
  buffer_load_dwordx4 a[8:11], v1, s[4:7], s52 offen offset:1024 sc1
  buffer_load_dwordx4 a[12:15], v1, s[4:7], s53 offen offset:1024 sc1
  buffer_load_dwordx4 a[16:19], v1, s[4:7], s52 offen offset:2048 sc1
  buffer_load_dwordx4 a[20:23], v1, s[4:7], s53 offen offset:2048 sc1
  buffer_load_dwordx4 a[24:27], v1, s[4:7], s52 offen offset:3072 sc1
  buffer_load_dwordx4 a[28:31], v1, s[4:7], s53 offen offset:3072 sc1
  s_add_u32 s52, s50, 4096
  buffer_load_dwordx4 a[32:35], v1, s[4:7], s52 offen offset:0 sc1
  s_add_u32 s53, s51, 4096
  buffer_load_dwordx4 a[36:39], v1, s[4:7], s53 offen offset:0 sc1
  buffer_load_dwordx4 a[40:43], v1, s[4:7], s52 offen offset:1024 sc1
  buffer_load_dwordx4 a[44:47], v1, s[4:7], s53 offen offset:1024 sc1
  ds_read_b128 v[16:19], v8 offset:40960
  ds_read_b128 v[20:23], v8 offset:41984
  ds_read_b128 v[24:27], v8 offset:43008
  ds_read_b128 v[28:31], v8 offset:44032
  ds_read_b128 v[32:35], v8 offset:45056
  s_waitcnt vmcnt(11) lgkmcnt(4)
  v_mfma_f32_16x16x32_bf16 v[48:51], v[16:19], a[0:3], 0
  ds_read_b128 v[36:39], v8 offset:51200
  s_waitcnt vmcnt(10)
  v_mfma_f32_16x16x32_bf16 v[52:55], v[16:19], a[4:7], 0
  s_waitcnt lgkmcnt(4)
  buffer_load_dwordx4 a[48:51], v1, s[4:7], s52 offen offset:2048 sc1
  v_mfma_f32_16x16x32_bf16 v[56:59], v[20:23], a[0:3], 0
  ds_read_b128 v[40:43], v8 offset:52224
  v_mfma_f32_16x16x32_bf16 v[60:63], v[20:23], a[4:7], 0
  s_waitcnt lgkmcnt(4)
  buffer_load_dwordx4 a[52:55], v1, s[4:7], s53 offen offset:2048 sc1
  v_mfma_f32_16x16x32_bf16 v[64:67], v[24:27], a[0:3], 0
  ds_read_b128 v[44:47], v8 offset:53248
  v_mfma_f32_16x16x32_bf16 v[68:71], v[24:27], a[4:7], 0
  s_waitcnt lgkmcnt(4)
  buffer_load_dwordx4 a[56:59], v1, s[4:7], s52 offen offset:3072 sc1
  v_mfma_f32_16x16x32_bf16 v[72:75], v[28:31], a[0:3], 0
  ds_read_b128 v[16:19], v8 offset:54272
  v_mfma_f32_16x16x32_bf16 v[76:79], v[28:31], a[4:7], 0
  s_waitcnt lgkmcnt(4)
  buffer_load_dwordx4 a[60:63], v1, s[4:7], s53 offen offset:3072 sc1
  v_mfma_f32_16x16x32_bf16 v[80:83], v[32:35], a[0:3], 0
  ds_read_b128 v[20:23], v8 offset:55296
  s_add_u32 s52, s50, 8192
  v_mfma_f32_16x16x32_bf16 v[84:87], v[32:35], a[4:7], 0
  s_waitcnt lgkmcnt(4)
  buffer_load_dwordx4 a[64:67], v1, s[4:7], s52 offen offset:0 sc1
  s_waitcnt vmcnt(14)
  v_mfma_f32_16x16x32_bf16 v[48:51], v[36:39], a[8:11], v[48:51]
  ds_read_b128 v[24:27], v9 offset:0
  s_add_u32 s53, s51, 8192
  s_waitcnt vmcnt(13)
  v_mfma_f32_16x16x32_bf16 v[52:55], v[36:39], a[12:15], v[52:55]
  s_waitcnt lgkmcnt(4)
  buffer_load_dwordx4 a[68:71], v1, s[4:7], s53 offen offset:0 sc1
  v_mfma_f32_16x16x32_bf16 v[56:59], v[40:43], a[8:11], v[56:59]
  ds_read_b128 v[28:31], v9 offset:1024
  v_mfma_f32_16x16x32_bf16 v[60:63], v[40:43], a[12:15], v[60:63]
  s_waitcnt lgkmcnt(4)
  buffer_load_dwordx4 a[72:75], v1, s[4:7], s52 offen offset:1024 sc1
  v_mfma_f32_16x16x32_bf16 v[64:67], v[44:47], a[8:11], v[64:67]
  ds_read_b128 v[32:35], v9 offset:2048
  v_mfma_f32_16x16x32_bf16 v[68:71], v[44:47], a[12:15], v[68:71]
  s_waitcnt lgkmcnt(4)
  buffer_load_dwordx4 a[76:79], v1, s[4:7], s53 offen offset:1024 sc1
  v_mfma_f32_16x16x32_bf16 v[72:75], v[16:19], a[8:11], v[72:75]
  ds_read_b128 v[36:39], v9 offset:3072
  v_mfma_f32_16x16x32_bf16 v[76:79], v[16:19], a[12:15], v[76:79]
  s_waitcnt lgkmcnt(4)
  v_mfma_f32_16x16x32_bf16 v[80:83], v[20:23], a[8:11], v[80:83]
  ds_read_b128 v[40:43], v9 offset:4096
  v_mfma_f32_16x16x32_bf16 v[84:87], v[20:23], a[12:15], v[84:87]
  s_waitcnt lgkmcnt(4)
  s_barrier
  s_waitcnt vmcnt(15)
  v_mfma_f32_16x16x32_bf16 v[48:51], v[24:27], a[16:19], v[48:51]
  ds_read_b128 v[44:47], v9 offset:10240
  s_waitcnt vmcnt(14)
  v_mfma_f32_16x16x32_bf16 v[52:55], v[24:27], a[20:23], v[52:55]
  s_waitcnt lgkmcnt(4)
  v_mfma_f32_16x16x32_bf16 v[56:59], v[28:31], a[16:19], v[56:59]
  ds_read_b128 v[16:19], v9 offset:11264
  v_mfma_f32_16x16x32_bf16 v[60:63], v[28:31], a[20:23], v[60:63]
  s_waitcnt lgkmcnt(4)
  v_mfma_f32_16x16x32_bf16 v[64:67], v[32:35], a[16:19], v[64:67]
  ds_read_b128 v[20:23], v9 offset:12288
  v_mfma_f32_16x16x32_bf16 v[68:71], v[32:35], a[20:23], v[68:71]
  s_waitcnt lgkmcnt(4)
  v_mfma_f32_16x16x32_bf16 v[72:75], v[36:39], a[16:19], v[72:75]
  ds_read_b128 v[24:27], v9 offset:13312
  v_mfma_f32_16x16x32_bf16 v[76:79], v[36:39], a[20:23], v[76:79]
  s_waitcnt lgkmcnt(4)
  v_mfma_f32_16x16x32_bf16 v[80:83], v[40:43], a[16:19], v[80:83]
  ds_read_b128 v[28:31], v9 offset:14336
  v_mfma_f32_16x16x32_bf16 v[84:87], v[40:43], a[20:23], v[84:87]
  s_waitcnt lgkmcnt(4)
  s_waitcnt vmcnt(13)
  v_mfma_f32_16x16x32_bf16 v[48:51], v[44:47], a[24:27], v[48:51]
  ds_read_b128 v[32:35], v9 offset:20480
  s_waitcnt vmcnt(12)
  v_mfma_f32_16x16x32_bf16 v[52:55], v[44:47], a[28:31], v[52:55]
  s_waitcnt lgkmcnt(4)
  v_mfma_f32_16x16x32_bf16 v[56:59], v[16:19], a[24:27], v[56:59]
  ds_read_b128 v[36:39], v9 offset:21504
  v_mfma_f32_16x16x32_bf16 v[60:63], v[16:19], a[28:31], v[60:63]
  s_waitcnt lgkmcnt(4)
  v_mfma_f32_16x16x32_bf16 v[64:67], v[20:23], a[24:27], v[64:67]
  ds_read_b128 v[40:43], v9 offset:22528
  v_mfma_f32_16x16x32_bf16 v[68:71], v[20:23], a[28:31], v[68:71]
  s_waitcnt lgkmcnt(4)
  v_mfma_f32_16x16x32_bf16 v[72:75], v[24:27], a[24:27], v[72:75]
  ds_read_b128 v[44:47], v9 offset:23552
  v_mfma_f32_16x16x32_bf16 v[76:79], v[24:27], a[28:31], v[76:79]
  s_waitcnt lgkmcnt(4)
  v_mfma_f32_16x16x32_bf16 v[80:83], v[28:31], a[24:27], v[80:83]
  ds_read_b128 v[16:19], v9 offset:24576
  v_mfma_f32_16x16x32_bf16 v[84:87], v[28:31], a[28:31], v[84:87]
  s_waitcnt lgkmcnt(4)
  s_barrier
  s_waitcnt vmcnt(11)
  v_mfma_f32_16x16x32_bf16 v[48:51], v[32:35], a[32:35], v[48:51]
  ds_read_b128 v[20:23], v9 offset:30720
  s_waitcnt vmcnt(10)
  v_mfma_f32_16x16x32_bf16 v[52:55], v[32:35], a[36:39], v[52:55]
  s_waitcnt lgkmcnt(4)
  v_mfma_f32_16x16x32_bf16 v[56:59], v[36:39], a[32:35], v[56:59]
  ds_read_b128 v[24:27], v9 offset:31744
  v_mfma_f32_16x16x32_bf16 v[60:63], v[36:39], a[36:39], v[60:63]
  s_waitcnt lgkmcnt(4)
  v_mfma_f32_16x16x32_bf16 v[64:67], v[40:43], a[32:35], v[64:67]
  ds_read_b128 v[28:31], v9 offset:32768
  v_mfma_f32_16x16x32_bf16 v[68:71], v[40:43], a[36:39], v[68:71]
  s_waitcnt lgkmcnt(4)
  v_mfma_f32_16x16x32_bf16 v[72:75], v[44:47], a[32:35], v[72:75]
  ds_read_b128 v[32:35], v9 offset:33792
  v_mfma_f32_16x16x32_bf16 v[76:79], v[44:47], a[36:39], v[76:79]
  s_waitcnt lgkmcnt(4)
  v_mfma_f32_16x16x32_bf16 v[80:83], v[16:19], a[32:35], v[80:83]
  ds_read_b128 v[36:39], v9 offset:34816
  v_mfma_f32_16x16x32_bf16 v[84:87], v[16:19], a[36:39], v[84:87]
  s_waitcnt lgkmcnt(4)
  s_waitcnt vmcnt(9)
  v_mfma_f32_16x16x32_bf16 v[48:51], v[20:23], a[40:43], v[48:51]
  ds_read_b128 v[40:43], v9 offset:40960
  s_waitcnt vmcnt(8)
  v_mfma_f32_16x16x32_bf16 v[52:55], v[20:23], a[44:47], v[52:55]
  s_waitcnt lgkmcnt(4)
  v_mfma_f32_16x16x32_bf16 v[56:59], v[24:27], a[40:43], v[56:59]
  ds_read_b128 v[44:47], v9 offset:41984
  v_mfma_f32_16x16x32_bf16 v[60:63], v[24:27], a[44:47], v[60:63]
  s_waitcnt lgkmcnt(4)
  v_mfma_f32_16x16x32_bf16 v[64:67], v[28:31], a[40:43], v[64:67]
  ds_read_b128 v[16:19], v9 offset:43008
  v_mfma_f32_16x16x32_bf16 v[68:71], v[28:31], a[44:47], v[68:71]
  s_waitcnt lgkmcnt(4)
  v_mfma_f32_16x16x32_bf16 v[72:75], v[32:35], a[40:43], v[72:75]
  ds_read_b128 v[20:23], v9 offset:44032
  v_mfma_f32_16x16x32_bf16 v[76:79], v[32:35], a[44:47], v[76:79]
  s_waitcnt lgkmcnt(4)
  v_mfma_f32_16x16x32_bf16 v[80:83], v[36:39], a[40:43], v[80:83]
  ds_read_b128 v[24:27], v9 offset:45056
  v_mfma_f32_16x16x32_bf16 v[84:87], v[36:39], a[44:47], v[84:87]
  s_waitcnt lgkmcnt(4)
  s_barrier
  s_waitcnt vmcnt(7)
  v_mfma_f32_16x16x32_bf16 v[48:51], v[40:43], a[48:51], v[48:51]
  ds_read_b128 v[28:31], v9 offset:51200
  v_lshlrev_b32 v112, 16, v240
  s_waitcnt vmcnt(6)
  v_mfma_f32_16x16x32_bf16 v[52:55], v[40:43], a[52:55], v[52:55]
  s_waitcnt lgkmcnt(4)
  v_and_b32 v113, 0xffff0000, v240
  v_lshlrev_b32 v114, 16, v241
  v_mfma_f32_16x16x32_bf16 v[56:59], v[44:47], a[48:51], v[56:59]
  ds_read_b128 v[32:35], v9 offset:52224
  v_and_b32 v115, 0xffff0000, v241
  v_mfma_f32_16x16x32_bf16 v[60:63], v[44:47], a[52:55], v[60:63]
  s_waitcnt lgkmcnt(4)
  v_lshlrev_b32 v116, 16, v242
  v_and_b32 v117, 0xffff0000, v242
  v_mfma_f32_16x16x32_bf16 v[64:67], v[16:19], a[48:51], v[64:67]
  ds_read_b128 v[36:39], v9 offset:53248
  v_lshlrev_b32 v118, 16, v243
  v_mfma_f32_16x16x32_bf16 v[68:71], v[16:19], a[52:55], v[68:71]
  s_waitcnt lgkmcnt(4)
  v_and_b32 v119, 0xffff0000, v243
  v_lshlrev_b32 v120, 16, v244
  v_mfma_f32_16x16x32_bf16 v[72:75], v[20:23], a[48:51], v[72:75]
  ds_read_b128 v[40:43], v9 offset:54272
  v_and_b32 v121, 0xffff0000, v244
  v_mfma_f32_16x16x32_bf16 v[76:79], v[20:23], a[52:55], v[76:79]
  s_waitcnt lgkmcnt(4)
  v_lshlrev_b32 v122, 16, v245
  v_and_b32 v123, 0xffff0000, v245
  v_mfma_f32_16x16x32_bf16 v[80:83], v[24:27], a[48:51], v[80:83]
  ds_read_b128 v[44:47], v9 offset:55296
  v_lshlrev_b32 v124, 16, v246
  v_mfma_f32_16x16x32_bf16 v[84:87], v[24:27], a[52:55], v[84:87]
  s_waitcnt lgkmcnt(4)
  v_and_b32 v125, 0xffff0000, v246
  v_lshlrev_b32 v126, 16, v247
  s_waitcnt vmcnt(5)
  v_mfma_f32_16x16x32_bf16 v[48:51], v[28:31], a[56:59], v[48:51]
  ds_read_b128 v[16:19], v8 offset:0
  v_and_b32 v127, 0xffff0000, v247
  s_waitcnt vmcnt(4)
  v_mfma_f32_16x16x32_bf16 v[52:55], v[28:31], a[60:63], v[52:55]
  s_waitcnt lgkmcnt(4)
  v_lshlrev_b32 v128, 16, v248
  v_and_b32 v129, 0xffff0000, v248
  v_mfma_f32_16x16x32_bf16 v[56:59], v[32:35], a[56:59], v[56:59]
  ds_read_b128 v[20:23], v8 offset:1024
  v_lshlrev_b32 v130, 16, v249
  v_mfma_f32_16x16x32_bf16 v[60:63], v[32:35], a[60:63], v[60:63]
  s_waitcnt lgkmcnt(4)
  v_and_b32 v131, 0xffff0000, v249
  v_mfma_f32_16x16x32_bf16 v[64:67], v[36:39], a[56:59], v[64:67]
  ds_read_b128 v[24:27], v8 offset:2048
  v_mfma_f32_16x16x32_bf16 v[68:71], v[36:39], a[60:63], v[68:71]
  s_waitcnt lgkmcnt(4)
  v_mfma_f32_16x16x32_bf16 v[72:75], v[40:43], a[56:59], v[72:75]
  ds_read_b128 v[28:31], v8 offset:3072
  v_mfma_f32_16x16x32_bf16 v[76:79], v[40:43], a[60:63], v[76:79]
  s_waitcnt lgkmcnt(4)
  v_mfma_f32_16x16x32_bf16 v[80:83], v[44:47], a[56:59], v[80:83]
  ds_read_b128 v[32:35], v8 offset:4096
  v_mfma_f32_16x16x32_bf16 v[84:87], v[44:47], a[60:63], v[84:87]
  s_waitcnt lgkmcnt(4)
  s_barrier
  s_waitcnt vmcnt(3)
  v_mfma_f32_16x16x32_bf16 v[48:51], v[16:19], a[64:67], v[48:51]
  ds_read_b128 v[36:39], v8 offset:10240
  s_waitcnt vmcnt(2)
  v_mfma_f32_16x16x32_bf16 v[52:55], v[16:19], a[68:71], v[52:55]
  s_waitcnt lgkmcnt(4)
  v_mfma_f32_16x16x32_bf16 v[56:59], v[20:23], a[64:67], v[56:59]
  ds_read_b128 v[40:43], v8 offset:11264
  v_mfma_f32_16x16x32_bf16 v[60:63], v[20:23], a[68:71], v[60:63]
  s_waitcnt lgkmcnt(4)
  v_mfma_f32_16x16x32_bf16 v[64:67], v[24:27], a[64:67], v[64:67]
  ds_read_b128 v[44:47], v8 offset:12288
  v_mfma_f32_16x16x32_bf16 v[68:71], v[24:27], a[68:71], v[68:71]
  s_waitcnt lgkmcnt(4)
  v_mfma_f32_16x16x32_bf16 v[72:75], v[28:31], a[64:67], v[72:75]
  ds_read_b128 v[16:19], v8 offset:13312
  v_mfma_f32_16x16x32_bf16 v[76:79], v[28:31], a[68:71], v[76:79]
  s_waitcnt lgkmcnt(4)
  v_mfma_f32_16x16x32_bf16 v[80:83], v[32:35], a[64:67], v[80:83]
  ds_read_b128 v[20:23], v8 offset:14336
  v_mfma_f32_16x16x32_bf16 v[84:87], v[32:35], a[68:71], v[84:87]
  s_waitcnt lgkmcnt(4)
  s_waitcnt vmcnt(1)
  v_mfma_f32_16x16x32_bf16 v[48:51], v[36:39], a[72:75], v[48:51]
  s_waitcnt vmcnt(0)
  v_mfma_f32_16x16x32_bf16 v[52:55], v[36:39], a[76:79], v[52:55]
  s_waitcnt lgkmcnt(3)
  v_mfma_f32_16x16x32_bf16 v[56:59], v[40:43], a[72:75], v[56:59]
  v_mfma_f32_16x16x32_bf16 v[60:63], v[40:43], a[76:79], v[60:63]
  s_waitcnt lgkmcnt(2)
  v_mfma_f32_16x16x32_bf16 v[64:67], v[44:47], a[72:75], v[64:67]
  v_mfma_f32_16x16x32_bf16 v[68:71], v[44:47], a[76:79], v[68:71]
  s_waitcnt lgkmcnt(1)
  v_mfma_f32_16x16x32_bf16 v[72:75], v[16:19], a[72:75], v[72:75]
  v_mfma_f32_16x16x32_bf16 v[76:79], v[16:19], a[76:79], v[76:79]
  s_waitcnt lgkmcnt(0)
  v_mfma_f32_16x16x32_bf16 v[80:83], v[20:23], a[72:75], v[80:83]
  v_mfma_f32_16x16x32_bf16 v[84:87], v[20:23], a[76:79], v[84:87]
  ds_write_b128 v255, v[52:55] offset:0
  ds_write_b128 v255, v[60:63] offset:1024
  ds_write_b128 v255, v[68:71] offset:2048
  s_nop 1
  ds_write_b128 v255, v[76:79] offset:3072
  s_nop 1
  ds_write_b128 v255, v[84:87] offset:4096
  s_waitcnt lgkmcnt(0)
  s_barrier
  ds_read_b128 v[88:91], v15 offset:0
  ds_read_b128 v[92:95], v15 offset:1024
  ds_read_b128 v[96:99], v15 offset:2048
  ds_read_b128 v[100:103], v15 offset:3072
  ds_read_b128 v[104:107], v15 offset:4096
  v_add_f32 v112, v112, v48
  v_add_f32 v113, v113, v49
  v_add_f32 v114, v114, v50
  v_add_f32 v115, v115, v51
  v_add_f32 v116, v116, v56
  v_add_f32 v117, v117, v57
  v_add_f32 v118, v118, v58
  v_add_f32 v119, v119, v59
  v_add_f32 v120, v120, v64
  v_add_f32 v121, v121, v65
  v_add_f32 v122, v122, v66
  v_add_f32 v123, v123, v67
  v_add_f32 v124, v124, v72
  v_add_f32 v125, v125, v73
  v_add_f32 v126, v126, v74
  v_add_f32 v127, v127, v75
  v_add_f32 v128, v128, v80
  v_add_f32 v129, v129, v81
  v_add_f32 v130, v130, v82
  v_add_f32 v131, v131, v83
  s_waitcnt lgkmcnt(4)
  v_add_f32 v112, v112, v88
  v_add_f32 v113, v113, v89
  v_add_f32 v114, v114, v90
  v_add_f32 v115, v115, v91
  s_waitcnt lgkmcnt(3)
  v_add_f32 v116, v116, v92
  v_add_f32 v117, v117, v93
  v_add_f32 v118, v118, v94
  v_add_f32 v119, v119, v95
  s_waitcnt lgkmcnt(2)
  v_add_f32 v120, v120, v96
  v_add_f32 v121, v121, v97
  v_add_f32 v122, v122, v98
  v_add_f32 v123, v123, v99
  s_waitcnt lgkmcnt(1)
  v_add_f32 v124, v124, v100
  v_add_f32 v125, v125, v101
  v_add_f32 v126, v126, v102
  v_add_f32 v127, v127, v103
  s_waitcnt lgkmcnt(0)
  v_add_f32 v128, v128, v104
  v_add_f32 v129, v129, v105
  v_add_f32 v130, v130, v106
  v_add_f32 v131, v131, v107
  v_cvt_pk_bf16_f32 v240, v112, v113
  v_cvt_pk_bf16_f32 v241, v114, v115
  v_cvt_pk_bf16_f32 v242, v116, v117
  v_cvt_pk_bf16_f32 v243, v118, v119
  v_cvt_pk_bf16_f32 v244, v120, v121
  v_cvt_pk_bf16_f32 v245, v122, v123
  v_cvt_pk_bf16_f32 v246, v124, v125
  v_cvt_pk_bf16_f32 v247, v126, v127
  v_cvt_pk_bf16_f32 v248, v128, v129
  v_cvt_pk_bf16_f32 v249, v130, v131
  s_mul_i32 s26, s45, 20480
  s_add_u32 s26, s26, s20
  s_add_u32 s26, s26, 0x520000
  buffer_store_dwordx4 v[240:243], v235, s[4:7], s26 offen sc1
  buffer_store_dwordx4 v[244:247], v236, s[4:7], s26 offen sc1
  buffer_store_dwordx2 v[248:249], v237, s[4:7], s26 offen sc1
  v_mov_b32 v136, 0
  v_mov_b32 v137, 0
  v_dot2c_f32_bf16 v136, v240, v3
  v_dot2c_f32_bf16 v137, v240, v240
  v_dot2c_f32_bf16 v136, v241, v3
  v_dot2c_f32_bf16 v137, v241, v241
  v_dot2c_f32_bf16 v136, v242, v3
  v_dot2c_f32_bf16 v137, v242, v242
  v_dot2c_f32_bf16 v136, v243, v3
  v_dot2c_f32_bf16 v137, v243, v243
  v_dot2c_f32_bf16 v136, v244, v3
  v_dot2c_f32_bf16 v137, v244, v244
  v_dot2c_f32_bf16 v136, v245, v3
  v_dot2c_f32_bf16 v137, v245, v245
  v_dot2c_f32_bf16 v136, v246, v3
  v_dot2c_f32_bf16 v137, v246, v246
  v_dot2c_f32_bf16 v136, v247, v3
  v_dot2c_f32_bf16 v137, v247, v247
  v_dot2c_f32_bf16 v136, v248, v3
  v_dot2c_f32_bf16 v137, v248, v248
  v_dot2c_f32_bf16 v136, v249, v3
  v_dot2c_f32_bf16 v137, v249, v249
  s_nop 1
  v_mov_b32 v138, v136
  v_mov_b32 v139, v137
  s_nop 0
  v_permlane16_swap_b32 v136, v138
  v_permlane16_swap_b32 v137, v139
  v_add_f32 v136, v136, v138
  v_add_f32 v137, v137, v139
  v_mov_b32 v138, v136
  v_mov_b32 v139, v137
  s_nop 0
  v_permlane32_swap_b32 v136, v138
  v_permlane32_swap_b32 v137, v139
  v_add_f32 v136, v136, v138
  v_add_f32 v137, v137, v139
  s_lshl_b32 s28, s45, 7
  s_lshl_b32 s29, s43, 14
  s_add_u32 s28, s28, s29
  s_add_u32 s28, s28, s20
  s_add_u32 s28, s28, 0x7a0000
  buffer_store_dwordx2 v[136:137], v253, s[4:7], s28 offen sc1
  s_mul_i32 s27, s17, 128
  s_add_u32 s27, s27, s3
  s_add_u32 s27, s27, 0x1800
  s_add_u32 m0, s21, 40960
  s_add_u32 s48, s24, 20480
  buffer_load_dwordx4 v1, s[4:7], s48 offen lds
  buffer_load_dwordx4 v1, s[4:7], s48 offen offset:1024 lds
  buffer_load_dwordx4 v1, s[4:7], s48 offen offset:2048 lds
  buffer_load_dwordx4 v1, s[4:7], s48 offen offset:3072 lds
  s_add_u32 m0, s21, 45056
  s_add_u32 s48, s24, 24576
  buffer_load_dwordx4 v1, s[4:7], s48 offen lds
  s_add_u32 m0, s21, 61440
  s_add_u32 s48, s24, 40960
  buffer_load_dwordx4 v1, s[4:7], s48 offen lds
  buffer_load_dwordx4 v1, s[4:7], s48 offen offset:1024 lds
  buffer_load_dwordx4 v1, s[4:7], s48 offen offset:2048 lds
  buffer_load_dwordx4 v1, s[4:7], s48 offen offset:3072 lds
  s_add_u32 m0, s21, 65536
  s_add_u32 s48, s24, 45056
  buffer_load_dwordx4 v1, s[4:7], s48 offen lds
  s_waitcnt vmcnt(10)
  s_barrier
  s_cmp_lg_u32 s16, 0
  s_cbranch_scc1 M_sig_14
  s_mov_b64 exec, 1
  buffer_atomic_add v5, v4, s[4:7], s27 offen sc1
  s_mov_b64 exec, -1
M_sig_14:
  s_mul_i32 s30, s18, 12288
  s_add_u32 s30, s30, 0x728000
  buffer_load_dwordx4 v[136:139], v1, s[4:7], s30 offen offset:0
  buffer_load_dwordx4 v[140:143], v1, s[4:7], s30 offen offset:1024
  buffer_load_dwordx4 v[144:147], v1, s[4:7], s30 offen offset:2048
  buffer_load_dwordx4 v[148:151], v1, s[4:7], s30 offen offset:3072
  s_cmp_eq_u32 s16, 0
  s_cbranch_scc1 M_side_15
  s_add_u32 m0, s21, 81920
  s_add_u32 s48, s24, 61440
  buffer_load_dwordx4 v1, s[4:7], s48 offen lds
  buffer_load_dwordx4 v1, s[4:7], s48 offen offset:1024 lds
  buffer_load_dwordx4 v1, s[4:7], s48 offen offset:2048 lds
  buffer_load_dwordx4 v1, s[4:7], s48 offen offset:3072 lds
  s_add_u32 m0, s21, 86016
  s_add_u32 s48, s24, 65536
  buffer_load_dwordx4 v1, s[4:7], s48 offen lds
  s_add_u32 m0, s56, 81920
  s_add_u32 s48, s24, 61440
  s_add_u32 s48, s48, s57
  buffer_load_dwordx4 v1, s[4:7], s48 offen lds
  buffer_load_dwordx4 v1, s[4:7], s48 offen offset:1024 lds
  s_add_u32 m0, s21, 102400
  s_add_u32 s48, s24, 81920
  buffer_load_dwordx4 v1, s[4:7], s48 offen lds
  buffer_load_dwordx4 v1, s[4:7], s48 offen offset:1024 lds
  buffer_load_dwordx4 v1, s[4:7], s48 offen offset:2048 lds
  buffer_load_dwordx4 v1, s[4:7], s48 offen offset:3072 lds
  s_add_u32 m0, s21, 106496
  s_add_u32 s48, s24, 86016
  buffer_load_dwordx4 v1, s[4:7], s48 offen lds
  s_add_u32 m0, s56, 102400
  s_add_u32 s48, s24, 81920
  s_add_u32 s48, s48, s57
  buffer_load_dwordx4 v1, s[4:7], s48 offen lds
  buffer_load_dwordx4 v1, s[4:7], s48 offen offset:1024 lds
M_side_15:
  s_mul_i32 s26, s17, 128
  s_add_u32 s26, s26, s3
  s_add_u32 s26, s26, 0x1800
  s_lshl_b32 s28, s17, 3
  s_lshl_b32 s27, s16, 1
  s_add_u32 s28, s28, s27
  s_lshl_b32 s27, s28, 7
  s_add_u32 s27, s27, s20
  s_add_u32 s27, s27, 0x7a0000
  s_mul_i32 s50, s28, 20480
  s_add_u32 s50, s50, s20
  s_add_u32 s50, s50, 0x520000
  s_add_u32 s51, s50, 20480
  s_mul_i32 s49, s28, 48
  s_add_u32 s49, s49, s18
  s_lshl_b32 s49, s49, 10
  s_add_u32 s49, s49, s20
  s_add_u32 s49, s49, 0x7c0000
  s_cmp_lg_u32 s16, 0
  s_cbranch_scc1 M_got_17
  s_cmp_lg_u32 s40, 0
  s_cbranch_scc1 M_got_17
  s_mov_b32 s41, 0
M_poll_16:
  buffer_load_dword v6, v4, s[4:7], s26 offen sc1
  s_waitcnt vmcnt(0)
  v_cmp_gt_u32 vcc, 16, v6
  s_nop 4
  s_cbranch_vccz M_got_17
  s_add_u32 s41, s41, 1
  s_cmp_lt_u32 s41, 40000
  s_cbranch_scc1 M_poll_16
  s_mov_b32 s40, 1
M_got_17:
  s_barrier
  s_add_u32 s52, s50, 0
  buffer_load_dwordx4 a[0:3], v1, s[4:7], s52 offen offset:0 sc1
  s_add_u32 s53, s51, 0
  buffer_load_dwordx4 a[4:7], v1, s[4:7], s53 offen offset:0 sc1
  buffer_load_dwordx4 a[8:11], v1, s[4:7], s52 offen offset:1024 sc1
  buffer_load_dwordx4 a[12:15], v1, s[4:7], s53 offen offset:1024 sc1
  buffer_load_dwordx4 a[16:19], v1, s[4:7], s52 offen offset:2048 sc1
  buffer_load_dwordx4 a[20:23], v1, s[4:7], s53 offen offset:2048 sc1
  buffer_load_dwordx4 a[24:27], v1, s[4:7], s52 offen offset:3072 sc1
  buffer_load_dwordx4 a[28:31], v1, s[4:7], s53 offen offset:3072 sc1
  s_add_u32 s52, s50, 4096
  buffer_load_dwordx4 a[32:35], v1, s[4:7], s52 offen offset:0 sc1
  s_add_u32 s53, s51, 4096
  buffer_load_dwordx4 a[36:39], v1, s[4:7], s53 offen offset:0 sc1
  buffer_load_dwordx4 a[40:43], v1, s[4:7], s52 offen offset:1024 sc1
  buffer_load_dwordx4 a[44:47], v1, s[4:7], s53 offen offset:1024 sc1
  buffer_load_dwordx4 a[48:51], v1, s[4:7], s52 offen offset:2048 sc1
  buffer_load_dwordx4 a[52:55], v1, s[4:7], s53 offen offset:2048 sc1
  buffer_load_dwordx4 a[56:59], v1, s[4:7], s52 offen offset:3072 sc1
  buffer_load_dwordx4 a[60:63], v1, s[4:7], s53 offen offset:3072 sc1
  s_add_u32 s52, s50, 8192
  buffer_load_dwordx4 a[64:67], v1, s[4:7], s52 offen offset:0 sc1
  s_add_u32 s53, s51, 8192
  buffer_load_dwordx4 a[68:71], v1, s[4:7], s53 offen offset:0 sc1
  s_mul_i32 s26, s17, 384
  s_add_u32 s26, s26, s3
  s_add_u32 s26, s26, 0x2000
  s_waitcnt vmcnt(27)
  s_barrier
  ds_read_b128 v[16:19], v1 offset:20480
  ds_read_b128 v[20:23], v1 offset:21504
  ds_read_b128 v[24:27], v1 offset:22528
  ds_read_b128 v[28:31], v1 offset:23552
  ds_read_b128 v[32:35], v1 offset:24576
  s_waitcnt vmcnt(17) lgkmcnt(4)
  v_mfma_f32_16x16x32_bf16 v[48:51], v[16:19], a[0:3], 0
  ds_read_b128 v[36:39], v1 offset:25600
  s_waitcnt vmcnt(16)
  v_mfma_f32_16x16x32_bf16 v[52:55], v[16:19], a[4:7], 0
  s_waitcnt lgkmcnt(4)
  buffer_load_dwordx4 a[72:75], v1, s[4:7], s52 offen offset:1024 sc1
  v_mfma_f32_16x16x32_bf16 v[56:59], v[20:23], a[0:3], 0
  ds_read_b128 v[40:43], v1 offset:26624
  v_mfma_f32_16x16x32_bf16 v[60:63], v[20:23], a[4:7], 0
  s_waitcnt lgkmcnt(4)
  v_mfma_f32_16x16x32_bf16 v[64:67], v[24:27], a[0:3], 0
  ds_read_b128 v[44:47], v1 offset:27648
  v_mfma_f32_16x16x32_bf16 v[68:71], v[24:27], a[4:7], 0
  s_waitcnt lgkmcnt(4)
  buffer_load_dwordx4 a[76:79], v1, s[4:7], s53 offen offset:1024 sc1
  v_mfma_f32_16x16x32_bf16 v[72:75], v[28:31], a[0:3], 0
  ds_read_b128 v[16:19], v1 offset:28672
  v_mfma_f32_16x16x32_bf16 v[76:79], v[28:31], a[4:7], 0
  s_waitcnt lgkmcnt(4)
  s_waitcnt vmcnt(17)
  v_mfma_f32_16x16x32_bf16 v[48:51], v[32:35], a[8:11], v[48:51]
  ds_read_b128 v[20:23], v1 offset:29696
  s_waitcnt vmcnt(16)
  v_mfma_f32_16x16x32_bf16 v[52:55], v[32:35], a[12:15], v[52:55]
  s_waitcnt lgkmcnt(4)
  buffer_load_dwordx4 a[80:83], v1, s[4:7], s52 offen offset:2048 sc1
  v_mfma_f32_16x16x32_bf16 v[56:59], v[36:39], a[8:11], v[56:59]
  ds_read_b128 v[24:27], v1 offset:30720
  v_mfma_f32_16x16x32_bf16 v[60:63], v[36:39], a[12:15], v[60:63]
  s_waitcnt lgkmcnt(4)
  v_mfma_f32_16x16x32_bf16 v[64:67], v[40:43], a[8:11], v[64:67]
  ds_read_b128 v[28:31], v1 offset:31744
  v_mfma_f32_16x16x32_bf16 v[68:71], v[40:43], a[12:15], v[68:71]
  s_waitcnt lgkmcnt(4)
  buffer_load_dwordx4 a[84:87], v1, s[4:7], s53 offen offset:2048 sc1
  v_mfma_f32_16x16x32_bf16 v[72:75], v[44:47], a[8:11], v[72:75]
  ds_read_b128 v[32:35], v1 offset:32768
  v_mfma_f32_16x16x32_bf16 v[76:79], v[44:47], a[12:15], v[76:79]
  s_waitcnt lgkmcnt(4)
  s_waitcnt vmcnt(17)
  v_mfma_f32_16x16x32_bf16 v[48:51], v[16:19], a[16:19], v[48:51]
  ds_read_b128 v[36:39], v1 offset:33792
  s_waitcnt vmcnt(16)
  v_mfma_f32_16x16x32_bf16 v[52:55], v[16:19], a[20:23], v[52:55]
  s_waitcnt lgkmcnt(4)
  buffer_load_dwordx4 a[88:91], v1, s[4:7], s52 offen offset:3072 sc1
  v_mfma_f32_16x16x32_bf16 v[56:59], v[20:23], a[16:19], v[56:59]
  ds_read_b128 v[40:43], v1 offset:34816
  v_mfma_f32_16x16x32_bf16 v[60:63], v[20:23], a[20:23], v[60:63]
  s_waitcnt lgkmcnt(4)
  v_mfma_f32_16x16x32_bf16 v[64:67], v[24:27], a[16:19], v[64:67]
  ds_read_b128 v[44:47], v1 offset:35840
  v_mfma_f32_16x16x32_bf16 v[68:71], v[24:27], a[20:23], v[68:71]
  s_waitcnt lgkmcnt(4)
  buffer_load_dwordx4 a[92:95], v1, s[4:7], s53 offen offset:3072 sc1
  v_mfma_f32_16x16x32_bf16 v[72:75], v[28:31], a[16:19], v[72:75]
  ds_read_b128 v[16:19], v1 offset:36864
  v_mfma_f32_16x16x32_bf16 v[76:79], v[28:31], a[20:23], v[76:79]
  s_waitcnt lgkmcnt(4)
  s_waitcnt vmcnt(17)
  v_mfma_f32_16x16x32_bf16 v[48:51], v[32:35], a[24:27], v[48:51]
  ds_read_b128 v[20:23], v1 offset:37888
  s_waitcnt vmcnt(16)
  v_mfma_f32_16x16x32_bf16 v[52:55], v[32:35], a[28:31], v[52:55]
  s_waitcnt lgkmcnt(4)
  buffer_load_dwordx2 v[112:113], v254, s[4:7], s27 offen offset:0 sc1
  v_mfma_f32_16x16x32_bf16 v[56:59], v[36:39], a[24:27], v[56:59]
  ds_read_b128 v[24:27], v1 offset:38912
  v_mfma_f32_16x16x32_bf16 v[60:63], v[36:39], a[28:31], v[60:63]
  s_waitcnt lgkmcnt(4)
  v_mfma_f32_16x16x32_bf16 v[64:67], v[40:43], a[24:27], v[64:67]
  ds_read_b128 v[28:31], v1 offset:39936
  v_mfma_f32_16x16x32_bf16 v[68:71], v[40:43], a[28:31], v[68:71]
  s_waitcnt lgkmcnt(4)
  buffer_load_dwordx2 v[116:117], v254, s[4:7], s27 offen offset:128 sc1
  v_mfma_f32_16x16x32_bf16 v[72:75], v[44:47], a[24:27], v[72:75]
  ds_read_b128 v[32:35], v1 offset:40960
  s_add_u32 s27, s27, 16384
  v_mfma_f32_16x16x32_bf16 v[76:79], v[44:47], a[28:31], v[76:79]
  s_waitcnt lgkmcnt(4)
  s_waitcnt vmcnt(17)
  v_mfma_f32_16x16x32_bf16 v[48:51], v[16:19], a[32:35], v[48:51]
  ds_read_b128 v[36:39], v1 offset:41984
  s_waitcnt vmcnt(16)
  v_mfma_f32_16x16x32_bf16 v[52:55], v[16:19], a[36:39], v[52:55]
  s_waitcnt lgkmcnt(4)
  buffer_load_dwordx2 v[114:115], v254, s[4:7], s27 offen offset:0 sc1
  v_mfma_f32_16x16x32_bf16 v[56:59], v[20:23], a[32:35], v[56:59]
  ds_read_b128 v[40:43], v1 offset:43008
  v_mfma_f32_16x16x32_bf16 v[60:63], v[20:23], a[36:39], v[60:63]
  s_waitcnt lgkmcnt(4)
  v_mfma_f32_16x16x32_bf16 v[64:67], v[24:27], a[32:35], v[64:67]
  ds_read_b128 v[44:47], v1 offset:44032
  v_mfma_f32_16x16x32_bf16 v[68:71], v[24:27], a[36:39], v[68:71]
  s_waitcnt lgkmcnt(4)
  buffer_load_dwordx2 v[118:119], v254, s[4:7], s27 offen offset:128 sc1
  v_mfma_f32_16x16x32_bf16 v[72:75], v[28:31], a[32:35], v[72:75]
  ds_read_b128 v[16:19], v1 offset:45056
  s_add_u32 s52, s50, 12288
  v_mfma_f32_16x16x32_bf16 v[76:79], v[28:31], a[36:39], v[76:79]
  s_waitcnt lgkmcnt(4)
  s_barrier
  s_waitcnt vmcnt(17)
  v_mfma_f32_16x16x32_bf16 v[48:51], v[32:35], a[40:43], v[48:51]
  ds_read_b128 v[20:23], v1 offset:46080
  s_waitcnt vmcnt(16)
  v_mfma_f32_16x16x32_bf16 v[52:55], v[32:35], a[44:47], v[52:55]
  s_waitcnt lgkmcnt(4)
  buffer_load_dwordx4 a[96:99], v1, s[4:7], s52 offen offset:0 sc1
  v_mfma_f32_16x16x32_bf16 v[56:59], v[36:39], a[40:43], v[56:59]
  ds_read_b128 v[24:27], v1 offset:47104
  s_add_u32 s53, s51, 12288
  v_mfma_f32_16x16x32_bf16 v[60:63], v[36:39], a[44:47], v[60:63]
  s_waitcnt lgkmcnt(4)
  v_mfma_f32_16x16x32_bf16 v[64:67], v[40:43], a[40:43], v[64:67]
  ds_read_b128 v[28:31], v1 offset:48128
  v_mfma_f32_16x16x32_bf16 v[68:71], v[40:43], a[44:47], v[68:71]
  s_waitcnt lgkmcnt(4)
  buffer_load_dwordx4 a[100:103], v1, s[4:7], s53 offen offset:0 sc1
  v_mfma_f32_16x16x32_bf16 v[72:75], v[44:47], a[40:43], v[72:75]
  ds_read_b128 v[32:35], v1 offset:49152
  v_mfma_f32_16x16x32_bf16 v[76:79], v[44:47], a[44:47], v[76:79]
  s_waitcnt lgkmcnt(4)
  s_waitcnt vmcnt(17)
  v_mfma_f32_16x16x32_bf16 v[48:51], v[16:19], a[48:51], v[48:51]
  ds_read_b128 v[36:39], v1 offset:50176
  s_waitcnt vmcnt(16)
  v_mfma_f32_16x16x32_bf16 v[52:55], v[16:19], a[52:55], v[52:55]
  s_waitcnt lgkmcnt(4)
  buffer_load_dwordx4 a[104:107], v1, s[4:7], s52 offen offset:1024 sc1
  v_mfma_f32_16x16x32_bf16 v[56:59], v[20:23], a[48:51], v[56:59]
  ds_read_b128 v[40:43], v1 offset:51200
  v_mfma_f32_16x16x32_bf16 v[60:63], v[20:23], a[52:55], v[60:63]
  s_waitcnt lgkmcnt(4)
  v_mfma_f32_16x16x32_bf16 v[64:67], v[24:27], a[48:51], v[64:67]
  ds_read_b128 v[44:47], v1 offset:52224
  v_mfma_f32_16x16x32_bf16 v[68:71], v[24:27], a[52:55], v[68:71]
  s_waitcnt lgkmcnt(4)
  buffer_load_dwordx4 a[108:111], v1, s[4:7], s53 offen offset:1024 sc1
  v_mfma_f32_16x16x32_bf16 v[72:75], v[28:31], a[48:51], v[72:75]
  ds_read_b128 v[16:19], v1 offset:53248
  v_mfma_f32_16x16x32_bf16 v[76:79], v[28:31], a[52:55], v[76:79]
  s_waitcnt lgkmcnt(4)
  s_waitcnt vmcnt(17)
  v_mfma_f32_16x16x32_bf16 v[48:51], v[32:35], a[56:59], v[48:51]
  ds_read_b128 v[20:23], v1 offset:54272
  s_waitcnt vmcnt(16)
  v_mfma_f32_16x16x32_bf16 v[52:55], v[32:35], a[60:63], v[52:55]
  s_waitcnt lgkmcnt(4)
  buffer_load_dwordx4 a[112:115], v1, s[4:7], s52 offen offset:2048 sc1
  v_mfma_f32_16x16x32_bf16 v[56:59], v[36:39], a[56:59], v[56:59]
  ds_read_b128 v[24:27], v1 offset:55296
  v_mfma_f32_16x16x32_bf16 v[60:63], v[36:39], a[60:63], v[60:63]
  s_waitcnt lgkmcnt(4)
  v_mfma_f32_16x16x32_bf16 v[64:67], v[40:43], a[56:59], v[64:67]
  ds_read_b128 v[28:31], v1 offset:56320
  v_mfma_f32_16x16x32_bf16 v[68:71], v[40:43], a[60:63], v[68:71]
  s_waitcnt lgkmcnt(4)
  buffer_load_dwordx4 a[116:119], v1, s[4:7], s53 offen offset:2048 sc1
  v_mfma_f32_16x16x32_bf16 v[72:75], v[44:47], a[56:59], v[72:75]
  ds_read_b128 v[32:35], v1 offset:57344
  v_mfma_f32_16x16x32_bf16 v[76:79], v[44:47], a[60:63], v[76:79]
  s_waitcnt lgkmcnt(4)
  s_waitcnt vmcnt(17)
  v_mfma_f32_16x16x32_bf16 v[48:51], v[16:19], a[64:67], v[48:51]
  ds_read_b128 v[36:39], v1 offset:58368
  s_waitcnt vmcnt(16)
  v_mfma_f32_16x16x32_bf16 v[52:55], v[16:19], a[68:71], v[52:55]
  s_waitcnt lgkmcnt(4)
  buffer_load_dwordx4 a[120:123], v1, s[4:7], s52 offen offset:3072 sc1
  v_mfma_f32_16x16x32_bf16 v[56:59], v[20:23], a[64:67], v[56:59]
  ds_read_b128 v[40:43], v1 offset:59392
  v_mfma_f32_16x16x32_bf16 v[60:63], v[20:23], a[68:71], v[60:63]
  s_waitcnt lgkmcnt(4)
  v_mfma_f32_16x16x32_bf16 v[64:67], v[24:27], a[64:67], v[64:67]
  ds_read_b128 v[44:47], v1 offset:60416
  v_mfma_f32_16x16x32_bf16 v[68:71], v[24:27], a[68:71], v[68:71]
  s_waitcnt lgkmcnt(4)
  buffer_load_dwordx4 a[124:127], v1, s[4:7], s53 offen offset:3072 sc1
  v_mfma_f32_16x16x32_bf16 v[72:75], v[28:31], a[64:67], v[72:75]
  ds_read_b128 v[16:19], v7 offset:0
  s_add_u32 m0, s21, 0
  v_mfma_f32_16x16x32_bf16 v[76:79], v[28:31], a[68:71], v[76:79]
  s_waitcnt lgkmcnt(4)
  s_add_u32 s48, s24, 102400
  s_waitcnt vmcnt(17)
  v_mfma_f32_16x16x32_bf16 v[48:51], v[32:35], a[72:75], v[48:51]
  ds_read_b128 v[20:23], v7 offset:1024
  s_waitcnt vmcnt(16)
  v_mfma_f32_16x16x32_bf16 v[52:55], v[32:35], a[76:79], v[52:55]
  s_waitcnt lgkmcnt(4)
  buffer_load_dwordx4 v1, s[4:7], s48 offen lds
  v_mfma_f32_16x16x32_bf16 v[56:59], v[36:39], a[72:75], v[56:59]
  ds_read_b128 v[24:27], v7 offset:2048
  v_mfma_f32_16x16x32_bf16 v[60:63], v[36:39], a[76:79], v[60:63]
  s_waitcnt lgkmcnt(4)
  v_mfma_f32_16x16x32_bf16 v[64:67], v[40:43], a[72:75], v[64:67]
  ds_read_b128 v[28:31], v7 offset:3072
  v_mfma_f32_16x16x32_bf16 v[68:71], v[40:43], a[76:79], v[68:71]
  s_waitcnt lgkmcnt(4)
  buffer_load_dwordx4 v1, s[4:7], s48 offen offset:1024 lds
  v_mfma_f32_16x16x32_bf16 v[72:75], v[44:47], a[72:75], v[72:75]
  ds_read_b128 v[32:35], v7 offset:4096
  v_mfma_f32_16x16x32_bf16 v[76:79], v[44:47], a[76:79], v[76:79]
  s_waitcnt lgkmcnt(4)
  s_barrier
  s_waitcnt vmcnt(17)
  v_mfma_f32_16x16x32_bf16 v[48:51], v[16:19], a[80:83], v[48:51]
  ds_read_b128 v[36:39], v7 offset:5120
  s_waitcnt vmcnt(16)
  v_mfma_f32_16x16x32_bf16 v[52:55], v[16:19], a[84:87], v[52:55]
  s_waitcnt lgkmcnt(4)
  buffer_load_dwordx4 v1, s[4:7], s48 offen offset:2048 lds
  v_mfma_f32_16x16x32_bf16 v[56:59], v[20:23], a[80:83], v[56:59]
  ds_read_b128 v[40:43], v7 offset:6144
  v_mfma_f32_16x16x32_bf16 v[60:63], v[20:23], a[84:87], v[60:63]
  s_waitcnt lgkmcnt(4)
  v_mfma_f32_16x16x32_bf16 v[64:67], v[24:27], a[80:83], v[64:67]
  ds_read_b128 v[44:47], v7 offset:7168
  v_mfma_f32_16x16x32_bf16 v[68:71], v[24:27], a[84:87], v[68:71]
  s_waitcnt lgkmcnt(4)
  buffer_load_dwordx4 v1, s[4:7], s48 offen offset:3072 lds
  v_mfma_f32_16x16x32_bf16 v[72:75], v[28:31], a[80:83], v[72:75]
  ds_read_b128 v[16:19], v7 offset:8192
  s_add_u32 m0, s21, 4096
  v_mfma_f32_16x16x32_bf16 v[76:79], v[28:31], a[84:87], v[76:79]
  s_waitcnt lgkmcnt(4)
  s_add_u32 s48, s24, 106496
  s_waitcnt vmcnt(17)
  v_mfma_f32_16x16x32_bf16 v[48:51], v[32:35], a[88:91], v[48:51]
  ds_read_b128 v[20:23], v7 offset:9216
  s_waitcnt vmcnt(16)
  v_mfma_f32_16x16x32_bf16 v[52:55], v[32:35], a[92:95], v[52:55]
  s_waitcnt lgkmcnt(4)
  buffer_load_dwordx4 v1, s[4:7], s48 offen lds
  v_mfma_f32_16x16x32_bf16 v[56:59], v[36:39], a[88:91], v[56:59]
  ds_read_b128 v[24:27], v7 offset:10240
  s_add_u32 s52, s50, 16384
  v_mfma_f32_16x16x32_bf16 v[60:63], v[36:39], a[92:95], v[60:63]
  s_waitcnt lgkmcnt(4)
  v_mfma_f32_16x16x32_bf16 v[64:67], v[40:43], a[88:91], v[64:67]
  ds_read_b128 v[28:31], v7 offset:11264
  v_mfma_f32_16x16x32_bf16 v[68:71], v[40:43], a[92:95], v[68:71]
  s_waitcnt lgkmcnt(4)
  buffer_load_dwordx4 a[128:131], v1, s[4:7], s52 offen offset:0 sc1
  v_mfma_f32_16x16x32_bf16 v[72:75], v[44:47], a[88:91], v[72:75]
  ds_read_b128 v[32:35], v7 offset:12288
  s_add_u32 s53, s51, 16384
  v_mfma_f32_16x16x32_bf16 v[76:79], v[44:47], a[92:95], v[76:79]
  s_waitcnt lgkmcnt(4)
  s_waitcnt vmcnt(13)
  v_mfma_f32_16x16x32_bf16 v[48:51], v[16:19], a[96:99], v[48:51]
  ds_read_b128 v[36:39], v7 offset:13312
  s_waitcnt vmcnt(12)
  v_mfma_f32_16x16x32_bf16 v[52:55], v[16:19], a[100:103], v[52:55]
  s_waitcnt lgkmcnt(4)
  buffer_load_dwordx4 a[132:135], v1, s[4:7], s53 offen offset:0 sc1
  v_mfma_f32_16x16x32_bf16 v[56:59], v[20:23], a[96:99], v[56:59]
  ds_read_b128 v[40:43], v7 offset:14336
  v_mfma_f32_16x16x32_bf16 v[60:63], v[20:23], a[100:103], v[60:63]
  s_waitcnt lgkmcnt(4)
  v_mfma_f32_16x16x32_bf16 v[64:67], v[24:27], a[96:99], v[64:67]
  ds_read_b128 v[44:47], v7 offset:15360
  v_mfma_f32_16x16x32_bf16 v[68:71], v[24:27], a[100:103], v[68:71]
  s_waitcnt lgkmcnt(4)
  buffer_load_dwordx4 a[136:139], v1, s[4:7], s52 offen offset:1024 sc1
  v_mfma_f32_16x16x32_bf16 v[72:75], v[28:31], a[96:99], v[72:75]
  ds_read_b128 v[16:19], v7 offset:16384
  v_mfma_f32_16x16x32_bf16 v[76:79], v[28:31], a[100:103], v[76:79]
  s_waitcnt lgkmcnt(4)
  s_waitcnt vmcnt(13)
  v_mfma_f32_16x16x32_bf16 v[48:51], v[32:35], a[104:107], v[48:51]
  ds_read_b128 v[20:23], v7 offset:17408
  s_waitcnt vmcnt(12)
  v_mfma_f32_16x16x32_bf16 v[52:55], v[32:35], a[108:111], v[52:55]
  s_waitcnt lgkmcnt(4)
  buffer_load_dwordx4 a[140:143], v1, s[4:7], s53 offen offset:1024 sc1
  v_mfma_f32_16x16x32_bf16 v[56:59], v[36:39], a[104:107], v[56:59]
  ds_read_b128 v[24:27], v7 offset:18432
  v_mfma_f32_16x16x32_bf16 v[60:63], v[36:39], a[108:111], v[60:63]
  s_waitcnt lgkmcnt(4)
  v_mfma_f32_16x16x32_bf16 v[64:67], v[40:43], a[104:107], v[64:67]
  ds_read_b128 v[28:31], v7 offset:19456
  v_mfma_f32_16x16x32_bf16 v[68:71], v[40:43], a[108:111], v[68:71]
  s_waitcnt lgkmcnt(4)
  buffer_load_dwordx4 a[144:147], v1, s[4:7], s52 offen offset:2048 sc1
  v_mfma_f32_16x16x32_bf16 v[72:75], v[44:47], a[104:107], v[72:75]
  ds_read_b128 v[32:35], v7 offset:20480
  v_mfma_f32_16x16x32_bf16 v[76:79], v[44:47], a[108:111], v[76:79]
  s_waitcnt lgkmcnt(4)
  s_waitcnt vmcnt(13)
  v_mfma_f32_16x16x32_bf16 v[48:51], v[16:19], a[112:115], v[48:51]
  ds_read_b128 v[36:39], v7 offset:21504
  v_add_f32 v112, v112, v114
  s_waitcnt vmcnt(12)
  v_mfma_f32_16x16x32_bf16 v[52:55], v[16:19], a[116:119], v[52:55]
  s_waitcnt lgkmcnt(4)
  buffer_load_dwordx4 a[148:151], v1, s[4:7], s53 offen offset:2048 sc1
  v_mfma_f32_16x16x32_bf16 v[56:59], v[20:23], a[112:115], v[56:59]
  ds_read_b128 v[40:43], v7 offset:22528
  v_add_f32 v113, v113, v115
  v_mfma_f32_16x16x32_bf16 v[60:63], v[20:23], a[116:119], v[60:63]
  s_waitcnt lgkmcnt(4)
  v_mov_b32 v114, v112
  v_mov_b32 v115, v113
  v_mfma_f32_16x16x32_bf16 v[64:67], v[24:27], a[112:115], v[64:67]
  ds_read_b128 v[44:47], v7 offset:23552
  v_permlane16_swap_b32 v112, v114
  v_mfma_f32_16x16x32_bf16 v[68:71], v[24:27], a[116:119], v[68:71]
  s_waitcnt lgkmcnt(4)
  buffer_load_dwordx4 a[152:155], v1, s[4:7], s52 offen offset:3072 sc1
  v_mfma_f32_16x16x32_bf16 v[72:75], v[28:31], a[112:115], v[72:75]
  ds_read_b128 v[16:19], v7 offset:24576
  v_permlane16_swap_b32 v113, v115
  v_mfma_f32_16x16x32_bf16 v[76:79], v[28:31], a[116:119], v[76:79]
  s_waitcnt lgkmcnt(4)
  v_add_f32 v112, v112, v114
  v_add_f32 v113, v113, v115
  s_barrier
  s_waitcnt vmcnt(13)
  v_mfma_f32_16x16x32_bf16 v[48:51], v[32:35], a[120:123], v[48:51]
  ds_read_b128 v[20:23], v7 offset:25600
  v_mov_b32 v114, v112
  s_waitcnt vmcnt(12)
  v_mfma_f32_16x16x32_bf16 v[52:55], v[32:35], a[124:127], v[52:55]
  s_waitcnt lgkmcnt(4)
  buffer_load_dwordx4 a[156:159], v1, s[4:7], s53 offen offset:3072 sc1
  v_mfma_f32_16x16x32_bf16 v[56:59], v[36:39], a[120:123], v[56:59]
  ds_read_b128 v[24:27], v7 offset:26624
  s_add_u32 m0, s21, 20480
  v_mfma_f32_16x16x32_bf16 v[60:63], v[36:39], a[124:127], v[60:63]
  s_waitcnt lgkmcnt(4)
  s_add_u32 s48, s24, 122880
  v_mov_b32 v115, v113
  v_mfma_f32_16x16x32_bf16 v[64:67], v[40:43], a[120:123], v[64:67]
  ds_read_b128 v[28:31], v7 offset:27648
  v_permlane32_swap_b32 v112, v114
  v_mfma_f32_16x16x32_bf16 v[68:71], v[40:43], a[124:127], v[68:71]
  s_waitcnt lgkmcnt(4)
  buffer_load_dwordx4 v1, s[4:7], s48 offen lds
  v_mfma_f32_16x16x32_bf16 v[72:75], v[44:47], a[120:123], v[72:75]
  ds_read_b128 v[32:35], v7 offset:28672
  v_permlane32_swap_b32 v113, v115
  v_mfma_f32_16x16x32_bf16 v[76:79], v[44:47], a[124:127], v[76:79]
  s_waitcnt lgkmcnt(4)
  v_add_f32 v112, v112, v114
  v_add_f32 v113, v113, v115
  s_waitcnt vmcnt(8)
  v_mfma_f32_16x16x32_bf16 v[48:51], v[16:19], a[128:131], v[48:51]
  ds_read_b128 v[36:39], v7 offset:29696
  v_mul_f32 v112, 0x3acccccd, v112
  s_waitcnt vmcnt(7)
  v_mfma_f32_16x16x32_bf16 v[52:55], v[16:19], a[132:135], v[52:55]
  s_waitcnt lgkmcnt(4)
  buffer_load_dwordx4 v1, s[4:7], s48 offen offset:1024 lds
  v_mfma_f32_16x16x32_bf16 v[56:59], v[20:23], a[128:131], v[56:59]
  ds_read_b128 v[40:43], v7 offset:30720
  v_mul_f32 v113, 0x3acccccd, v113
  v_mfma_f32_16x16x32_bf16 v[60:63], v[20:23], a[132:135], v[60:63]
  s_waitcnt lgkmcnt(4)
  v_fma_f32 v113, -v112, v112, v113
  v_max_f32 v113, 0, v113
  v_mfma_f32_16x16x32_bf16 v[64:67], v[24:27], a[128:131], v[64:67]
  ds_read_b128 v[44:47], v7 offset:31744
  v_add_f32 v122, 0x3727c5ac, v113
  v_mfma_f32_16x16x32_bf16 v[68:71], v[24:27], a[132:135], v[68:71]
  s_waitcnt lgkmcnt(4)
  buffer_load_dwordx4 v1, s[4:7], s48 offen offset:2048 lds
  v_mfma_f32_16x16x32_bf16 v[72:75], v[28:31], a[128:131], v[72:75]
  ds_read_b128 v[16:19], v7 offset:32768
  v_mfma_f32_16x16x32_bf16 v[76:79], v[28:31], a[132:135], v[76:79]
  s_waitcnt lgkmcnt(4)
  v_rsq_f32 v120, v122
  s_waitcnt vmcnt(8)
  v_mfma_f32_16x16x32_bf16 v[48:51], v[32:35], a[136:139], v[48:51]
  ds_read_b128 v[20:23], v7 offset:33792
  v_cvt_pk_bf16_f32 v114, -v112, -v112
  s_waitcnt vmcnt(7)
  v_mfma_f32_16x16x32_bf16 v[52:55], v[32:35], a[140:143], v[52:55]
  s_waitcnt lgkmcnt(4)
  buffer_load_dwordx4 v1, s[4:7], s48 offen offset:3072 lds
  v_mfma_f32_16x16x32_bf16 v[56:59], v[36:39], a[136:139], v[56:59]
  ds_read_b128 v[24:27], v7 offset:34816
  s_add_u32 m0, s21, 24576
  v_mfma_f32_16x16x32_bf16 v[60:63], v[36:39], a[140:143], v[60:63]
  s_waitcnt lgkmcnt(4)
  s_add_u32 s48, s24, 126976
  v_and_b32 v114, 0xffff0000, v114
  v_mfma_f32_16x16x32_bf16 v[64:67], v[40:43], a[136:139], v[64:67]
  ds_read_b128 v[28:31], v7 offset:35840
  v_sub_f32 v114, -v112, v114
  v_mfma_f32_16x16x32_bf16 v[68:71], v[40:43], a[140:143], v[68:71]
  s_waitcnt lgkmcnt(4)
  buffer_load_dwordx4 v1, s[4:7], s48 offen lds
  v_mfma_f32_16x16x32_bf16 v[72:75], v[44:47], a[136:139], v[72:75]
  ds_read_b128 v[32:35], v7 offset:36864
  s_add_u32 m0, s21, 40960
  v_mfma_f32_16x16x32_bf16 v[76:79], v[44:47], a[140:143], v[76:79]
  s_waitcnt lgkmcnt(4)
  s_add_u32 s48, s24, 143360
  v_cvt_pk_bf16_f32 v124, -v112, v114
  s_waitcnt vmcnt(8)
  v_mfma_f32_16x16x32_bf16 v[48:51], v[16:19], a[144:147], v[48:51]
  ds_read_b128 v[36:39], v7 offset:37888
  v_mov_b32 v125, v124
  s_waitcnt vmcnt(7)
  v_mfma_f32_16x16x32_bf16 v[52:55], v[16:19], a[148:151], v[52:55]
  s_waitcnt lgkmcnt(4)
  buffer_load_dwordx4 v1, s[4:7], s48 offen lds
  v_mfma_f32_16x16x32_bf16 v[56:59], v[20:23], a[144:147], v[56:59]
  ds_read_b128 v[40:43], v7 offset:38912
  v_mov_b32 v126, v124
  v_mfma_f32_16x16x32_bf16 v[60:63], v[20:23], a[148:151], v[60:63]
  s_waitcnt lgkmcnt(4)
  v_mov_b32 v127, v124
  v_mul_f32 v176, 0xc0135761, v120
  v_mfma_f32_16x16x32_bf16 v[64:67], v[24:27], a[144:147], v[64:67]
  ds_read_b128 v[44:47], v7 offset:39936
  v_mul_f32 v178, v120, v120
  v_mfma_f32_16x16x32_bf16 v[68:71], v[24:27], a[148:151], v[68:71]
  s_waitcnt lgkmcnt(4)
  buffer_load_dwordx4 v1, s[4:7], s48 offen offset:1024 lds
  v_mfma_f32_16x16x32_bf16 v[72:75], v[28:31], a[144:147], v[72:75]
  ds_read_b128 v[16:19], v7 offset:40960
  v_mul_f32 v178, v178, v176
  v_mfma_f32_16x16x32_bf16 v[76:79], v[28:31], a[148:151], v[76:79]
  s_waitcnt lgkmcnt(4)
  v_mul_f32 v178, 0x3d372713, v178
  v_add_f32 v116, v116, v118
  s_waitcnt vmcnt(8)
  v_mfma_f32_16x16x32_bf16 v[48:51], v[32:35], a[152:155], v[48:51]
  ds_read_b128 v[20:23], v7 offset:41984
  v_add_f32 v117, v117, v119
  s_waitcnt vmcnt(7)
  v_mfma_f32_16x16x32_bf16 v[52:55], v[32:35], a[156:159], v[52:55]
  s_waitcnt lgkmcnt(4)
  buffer_load_dwordx4 v1, s[4:7], s48 offen offset:2048 lds
  v_mfma_f32_16x16x32_bf16 v[56:59], v[36:39], a[152:155], v[56:59]
  ds_read_b128 v[24:27], v7 offset:43008
  v_mov_b32 v118, v116
  v_mfma_f32_16x16x32_bf16 v[60:63], v[36:39], a[156:159], v[60:63]
  s_waitcnt lgkmcnt(4)
  v_mov_b32 v119, v117
  v_permlane16_swap_b32 v116, v118
  v_mfma_f32_16x16x32_bf16 v[64:67], v[40:43], a[152:155], v[64:67]
  ds_read_b128 v[28:31], v7 offset:44032
  v_permlane16_swap_b32 v117, v119
  v_mfma_f32_16x16x32_bf16 v[68:71], v[40:43], a[156:159], v[68:71]
  s_waitcnt lgkmcnt(4)
  buffer_load_dwordx4 v1, s[4:7], s48 offen offset:3072 lds
  v_mfma_f32_16x16x32_bf16 v[72:75], v[44:47], a[152:155], v[72:75]
  ds_read_b128 v[32:35], v7 offset:45056
  s_add_u32 m0, s21, 45056
  v_mfma_f32_16x16x32_bf16 v[76:79], v[44:47], a[156:159], v[76:79]
  s_waitcnt lgkmcnt(4)
  s_add_u32 s48, s24, 147456
  v_add_f32 v116, v116, v118
  v_add_f32 v117, v117, v119
  v_mov_b32 v118, v116
  v_mov_b32 v119, v117
  s_nop 0
  v_permlane32_swap_b32 v116, v118
  v_permlane32_swap_b32 v117, v119
  v_add_f32 v116, v116, v118
  v_add_f32 v117, v117, v119
  v_mul_f32 v116, 0x3acccccd, v116
  v_mul_f32 v117, 0x3acccccd, v117
  v_fma_f32 v117, -v116, v116, v117
  v_max_f32 v117, 0, v117
  v_add_f32 v123, 0x3727c5ac, v117
  v_rsq_f32 v121, v123
  v_cvt_pk_bf16_f32 v118, -v116, -v116
  v_and_b32 v118, 0xffff0000, v118
  v_sub_f32 v118, -v116, v118
  v_cvt_pk_bf16_f32 v132, -v116, v118
  v_mov_b32 v133, v132
  v_mov_b32 v134, v132
  v_mov_b32 v135, v132
  v_mul_f32 v177, 0xc0135761, v121
  v_mul_f32 v179, v121, v121
  v_mul_f32 v179, v179, v177
  v_mul_f32 v179, 0x3d372713, v179
  s_barrier
  v_mfma_f32_16x16x32_bf16 v[48:51], v[136:139], v[124:127], v[48:51]
  v_mfma_f32_16x16x32_bf16 v[52:55], v[136:139], v[132:135], v[52:55]
  buffer_load_dwordx4 v1, s[4:7], s48 offen lds
  v_mfma_f32_16x16x32_bf16 v[56:59], v[140:143], v[124:127], v[56:59]
  s_add_u32 m0, s21, 61440
  s_add_u32 s48, s24, 163840
  v_mfma_f32_16x16x32_bf16 v[60:63], v[140:143], v[132:135], v[60:63]
  v_mfma_f32_16x16x32_bf16 v[64:67], v[144:147], v[124:127], v[64:67]
  v_mfma_f32_16x16x32_bf16 v[68:71], v[144:147], v[132:135], v[68:71]
  buffer_load_dwordx4 v1, s[4:7], s48 offen lds
  v_mfma_f32_16x16x32_bf16 v[72:75], v[148:151], v[124:127], v[72:75]
  v_mfma_f32_16x16x32_bf16 v[76:79], v[148:151], v[132:135], v[76:79]
  v_mfma_f32_16x16x32_bf16 v[80:83], v[16:19], a[0:3], 0
  ds_read_b128 v[36:39], v7 offset:46080
  v_mfma_f32_16x16x32_bf16 v[84:87], v[16:19], a[4:7], 0
  s_waitcnt lgkmcnt(4)
  buffer_load_dwordx4 v1, s[4:7], s48 offen offset:1024 lds
  v_mfma_f32_16x16x32_bf16 v[88:91], v[20:23], a[0:3], 0
  ds_read_b128 v[40:43], v7 offset:47104
  v_mul_f32 v160, v48, v48
  v_mfma_f32_16x16x32_bf16 v[92:95], v[20:23], a[4:7], 0
  s_waitcnt lgkmcnt(4)
  v_mul_f32 v161, v49, v49
  v_mul_f32 v162, v50, v50
  v_mfma_f32_16x16x32_bf16 v[96:99], v[24:27], a[0:3], 0
  ds_read_b128 v[44:47], v7 offset:48128
  v_mul_f32 v163, v51, v51
  v_mfma_f32_16x16x32_bf16 v[100:103], v[24:27], a[4:7], 0
  s_waitcnt lgkmcnt(4)
  buffer_load_dwordx4 v1, s[4:7], s48 offen offset:2048 lds
  v_mfma_f32_16x16x32_bf16 v[104:107], v[28:31], a[0:3], 0
  ds_read_b128 v[16:19], v7 offset:49152
  v_fma_f32 v160, v160, v178, v176
  v_mfma_f32_16x16x32_bf16 v[108:111], v[28:31], a[4:7], 0
  s_waitcnt lgkmcnt(4)
  v_fma_f32 v161, v161, v178, v176
  v_fma_f32 v162, v162, v178, v176
  v_mfma_f32_16x16x32_bf16 v[80:83], v[32:35], a[8:11], v[80:83]
  ds_read_b128 v[20:23], v7 offset:50176
  v_fma_f32 v163, v163, v178, v176
  v_mfma_f32_16x16x32_bf16 v[84:87], v[32:35], a[12:15], v[84:87]
  s_waitcnt lgkmcnt(4)
  buffer_load_dwordx4 v1, s[4:7], s48 offen offset:3072 lds
  v_mfma_f32_16x16x32_bf16 v[88:91], v[36:39], a[8:11], v[88:91]
  ds_read_b128 v[24:27], v7 offset:51200
  s_add_u32 m0, s21, 65536
  v_mfma_f32_16x16x32_bf16 v[92:95], v[36:39], a[12:15], v[92:95]
  s_waitcnt lgkmcnt(4)
  s_add_u32 s48, s24, 167936
  v_mul_f32 v160, v160, v48
  v_mfma_f32_16x16x32_bf16 v[96:99], v[40:43], a[8:11], v[96:99]
  ds_read_b128 v[28:31], v7 offset:52224
  v_mul_f32 v161, v161, v49
  v_mfma_f32_16x16x32_bf16 v[100:103], v[40:43], a[12:15], v[100:103]
  s_waitcnt lgkmcnt(4)
  buffer_load_dwordx4 v1, s[4:7], s48 offen lds
  v_mfma_f32_16x16x32_bf16 v[104:107], v[44:47], a[8:11], v[104:107]
  ds_read_b128 v[32:35], v7 offset:53248
  s_add_u32 m0, s21, 81920
  v_mfma_f32_16x16x32_bf16 v[108:111], v[44:47], a[12:15], v[108:111]
  s_waitcnt lgkmcnt(4)
  s_add_u32 s48, s24, 184320
  v_mul_f32 v162, v162, v50
  v_mfma_f32_16x16x32_bf16 v[80:83], v[16:19], a[16:19], v[80:83]
  ds_read_b128 v[36:39], v7 offset:54272
  v_mul_f32 v163, v163, v51
  v_mfma_f32_16x16x32_bf16 v[84:87], v[16:19], a[20:23], v[84:87]
  s_waitcnt lgkmcnt(4)
  buffer_load_dwordx4 v1, s[4:7], s48 offen lds
  v_mfma_f32_16x16x32_bf16 v[88:91], v[20:23], a[16:19], v[88:91]
  ds_read_b128 v[40:43], v7 offset:55296
  v_mfma_f32_16x16x32_bf16 v[92:95], v[20:23], a[20:23], v[92:95]
  s_waitcnt lgkmcnt(4)
  v_exp_f32 v160, v160
  v_mfma_f32_16x16x32_bf16 v[96:99], v[24:27], a[16:19], v[96:99]
  ds_read_b128 v[44:47], v7 offset:56320
  v_mul_f32 v152, v48, v64
  v_mfma_f32_16x16x32_bf16 v[100:103], v[24:27], a[20:23], v[100:103]
  s_waitcnt lgkmcnt(4)
  buffer_load_dwordx4 v1, s[4:7], s48 offen offset:1024 lds
  v_mfma_f32_16x16x32_bf16 v[104:107], v[28:31], a[16:19], v[104:107]
  ds_read_b128 v[16:19], v7 offset:57344
  v_mfma_f32_16x16x32_bf16 v[108:111], v[28:31], a[20:23], v[108:111]
  s_waitcnt lgkmcnt(4)
  v_exp_f32 v161, v161
  v_mfma_f32_16x16x32_bf16 v[80:83], v[32:35], a[24:27], v[80:83]
  ds_read_b128 v[20:23], v7 offset:58368
  v_mul_f32 v153, v49, v65
  v_mfma_f32_16x16x32_bf16 v[84:87], v[32:35], a[28:31], v[84:87]
  s_waitcnt lgkmcnt(4)
  buffer_load_dwordx4 v1, s[4:7], s48 offen offset:2048 lds
  v_mfma_f32_16x16x32_bf16 v[88:91], v[36:39], a[24:27], v[88:91]
  ds_read_b128 v[24:27], v7 offset:59392
  v_mfma_f32_16x16x32_bf16 v[92:95], v[36:39], a[28:31], v[92:95]
  s_waitcnt lgkmcnt(4)
  v_exp_f32 v162, v162
  v_mfma_f32_16x16x32_bf16 v[96:99], v[40:43], a[24:27], v[96:99]
  ds_read_b128 v[28:31], v7 offset:60416
  v_mul_f32 v154, v50, v66
  v_mfma_f32_16x16x32_bf16 v[100:103], v[40:43], a[28:31], v[100:103]
  s_waitcnt lgkmcnt(4)
  buffer_load_dwordx4 v1, s[4:7], s48 offen offset:3072 lds
  v_mfma_f32_16x16x32_bf16 v[104:107], v[44:47], a[24:27], v[104:107]
  ds_read_b128 v[32:35], v1 offset:0
  s_add_u32 m0, s21, 86016
  v_mfma_f32_16x16x32_bf16 v[108:111], v[44:47], a[28:31], v[108:111]
  s_waitcnt lgkmcnt(4)
  s_add_u32 s48, s24, 188416
  v_mfma_f32_16x16x32_bf16 v[80:83], v[16:19], a[32:35], v[80:83]
  ds_read_b128 v[36:39], v1 offset:1024
  v_mfma_f32_16x16x32_bf16 v[84:87], v[16:19], a[36:39], v[84:87]
  s_waitcnt lgkmcnt(4)
  buffer_load_dwordx4 v1, s[4:7], s48 offen lds
  v_mfma_f32_16x16x32_bf16 v[88:91], v[20:23], a[32:35], v[88:91]
  ds_read_b128 v[40:43], v1 offset:2048
  s_add_u32 s30, s30, 4096
  v_mfma_f32_16x16x32_bf16 v[92:95], v[20:23], a[36:39], v[92:95]
  s_waitcnt lgkmcnt(4)
  v_exp_f32 v163, v163
  v_mfma_f32_16x16x32_bf16 v[96:99], v[24:27], a[32:35], v[96:99]
  ds_read_b128 v[44:47], v1 offset:3072
  v_mul_f32 v155, v51, v67
  v_mfma_f32_16x16x32_bf16 v[100:103], v[24:27], a[36:39], v[100:103]
  s_waitcnt lgkmcnt(4)
  buffer_load_dwordx4 v[136:139], v1, s[4:7], s30 offen offset:0
  v_mfma_f32_16x16x32_bf16 v[104:107], v[28:31], a[32:35], v[104:107]
  ds_read_b128 v[16:19], v1 offset:4096
  v_fma_f32 v160, v160, v122, v122
  v_mfma_f32_16x16x32_bf16 v[108:111], v[28:31], a[36:39], v[108:111]
  s_waitcnt lgkmcnt(4)
  v_fma_f32 v161, v161, v122, v122
  v_fma_f32 v162, v162, v122, v122
  s_waitcnt vmcnt(16)
  s_barrier
  v_mfma_f32_16x16x32_bf16 v[80:83], v[32:35], a[40:43], v[80:83]
  ds_read_b128 v[20:23], v1 offset:5120
  v_fma_f32 v163, v163, v122, v122
  v_mfma_f32_16x16x32_bf16 v[84:87], v[32:35], a[44:47], v[84:87]
  s_waitcnt lgkmcnt(4)
  buffer_load_dwordx4 v[140:143], v1, s[4:7], s30 offen offset:1024
  v_mfma_f32_16x16x32_bf16 v[88:91], v[36:39], a[40:43], v[88:91]
  ds_read_b128 v[24:27], v1 offset:6144
  v_mfma_f32_16x16x32_bf16 v[92:95], v[36:39], a[44:47], v[92:95]
  s_waitcnt lgkmcnt(4)
  v_rcp_f32 v160, v160
  v_mfma_f32_16x16x32_bf16 v[96:99], v[40:43], a[40:43], v[96:99]
  ds_read_b128 v[28:31], v1 offset:7168
  v_mfma_f32_16x16x32_bf16 v[100:103], v[40:43], a[44:47], v[100:103]
  s_waitcnt lgkmcnt(4)
  buffer_load_dwordx4 v[144:147], v1, s[4:7], s30 offen offset:2048
  v_mfma_f32_16x16x32_bf16 v[104:107], v[44:47], a[40:43], v[104:107]
  ds_read_b128 v[32:35], v1 offset:8192
  v_mfma_f32_16x16x32_bf16 v[108:111], v[44:47], a[44:47], v[108:111]
  s_waitcnt lgkmcnt(4)
  v_rcp_f32 v161, v161
  v_mfma_f32_16x16x32_bf16 v[80:83], v[16:19], a[48:51], v[80:83]
  ds_read_b128 v[36:39], v1 offset:9216
  v_mfma_f32_16x16x32_bf16 v[84:87], v[16:19], a[52:55], v[84:87]
  s_waitcnt lgkmcnt(4)
  buffer_load_dwordx4 v[148:151], v1, s[4:7], s30 offen offset:3072
  v_mfma_f32_16x16x32_bf16 v[88:91], v[20:23], a[48:51], v[88:91]
  ds_read_b128 v[40:43], v1 offset:10240
  s_add_u32 m0, s21, 102400
  v_mfma_f32_16x16x32_bf16 v[92:95], v[20:23], a[52:55], v[92:95]
  s_waitcnt lgkmcnt(4)
  s_add_u32 s48, s24, 204800
  v_mfma_f32_16x16x32_bf16 v[96:99], v[24:27], a[48:51], v[96:99]
  ds_read_b128 v[44:47], v1 offset:11264
  v_mfma_f32_16x16x32_bf16 v[100:103], v[24:27], a[52:55], v[100:103]
  s_waitcnt lgkmcnt(4)
  buffer_load_dwordx4 v1, s[4:7], s48 offen lds
  v_mfma_f32_16x16x32_bf16 v[104:107], v[28:31], a[48:51], v[104:107]
  ds_read_b128 v[16:19], v1 offset:12288
  v_mfma_f32_16x16x32_bf16 v[108:111], v[28:31], a[52:55], v[108:111]
  s_waitcnt lgkmcnt(4)
  v_rcp_f32 v162, v162
  v_mfma_f32_16x16x32_bf16 v[80:83], v[32:35], a[56:59], v[80:83]
  ds_read_b128 v[20:23], v1 offset:13312
  v_mfma_f32_16x16x32_bf16 v[84:87], v[32:35], a[60:63], v[84:87]
  s_waitcnt lgkmcnt(4)
  buffer_load_dwordx4 v1, s[4:7], s48 offen offset:1024 lds
  v_mfma_f32_16x16x32_bf16 v[88:91], v[36:39], a[56:59], v[88:91]
  ds_read_b128 v[24:27], v1 offset:14336
  v_mfma_f32_16x16x32_bf16 v[92:95], v[36:39], a[60:63], v[92:95]
  s_waitcnt lgkmcnt(4)
  v_rcp_f32 v163, v163
  v_mfma_f32_16x16x32_bf16 v[96:99], v[40:43], a[56:59], v[96:99]
  ds_read_b128 v[28:31], v1 offset:15360
  v_mul_f32 v152, v152, v160
  v_mfma_f32_16x16x32_bf16 v[100:103], v[40:43], a[60:63], v[100:103]
  s_waitcnt lgkmcnt(4)
  buffer_load_dwordx4 v1, s[4:7], s48 offen offset:2048 lds
  v_mfma_f32_16x16x32_bf16 v[104:107], v[44:47], a[56:59], v[104:107]
  ds_read_b128 v[32:35], v1 offset:16384
  v_mul_f32 v153, v153, v161
  v_mfma_f32_16x16x32_bf16 v[108:111], v[44:47], a[60:63], v[108:111]
  s_waitcnt lgkmcnt(4)
  v_mul_f32 v154, v154, v162
  v_mul_f32 v155, v155, v163
  v_mfma_f32_16x16x32_bf16 v[80:83], v[16:19], a[64:67], v[80:83]
  ds_read_b128 v[36:39], v1 offset:17408
  v_cvt_pk_bf16_f32 v168, v152, v153
  v_mfma_f32_16x16x32_bf16 v[84:87], v[16:19], a[68:71], v[84:87]
  s_waitcnt lgkmcnt(4)
  buffer_load_dwordx4 v1, s[4:7], s48 offen offset:3072 lds
  v_mfma_f32_16x16x32_bf16 v[88:91], v[20:23], a[64:67], v[88:91]
  ds_read_b128 v[40:43], v1 offset:18432
  s_add_u32 m0, s21, 106496
  v_mfma_f32_16x16x32_bf16 v[92:95], v[20:23], a[68:71], v[92:95]
  s_waitcnt lgkmcnt(4)
  s_add_u32 s48, s24, 208896
  v_cvt_pk_bf16_f32 v169, v154, v155
  v_mfma_f32_16x16x32_bf16 v[96:99], v[24:27], a[64:67], v[96:99]
  ds_read_b128 v[44:47], v1 offset:19456
  v_mul_f32 v164, v56, v56
  v_mfma_f32_16x16x32_bf16 v[100:103], v[24:27], a[68:71], v[100:103]
  s_waitcnt lgkmcnt(4)
  buffer_load_dwordx4 v1, s[4:7], s48 offen lds
  v_mfma_f32_16x16x32_bf16 v[104:107], v[28:31], a[64:67], v[104:107]
  ds_read_b128 v[16:19], v1 offset:20480
  s_add_u32 m0, s21, 122880
  v_mfma_f32_16x16x32_bf16 v[108:111], v[28:31], a[68:71], v[108:111]
  s_waitcnt lgkmcnt(4)
  s_add_u32 s48, s25, 0
  v_mul_f32 v165, v57, v57
  v_mfma_f32_16x16x32_bf16 v[80:83], v[32:35], a[72:75], v[80:83]
  ds_read_b128 v[20:23], v1 offset:21504
  v_mul_f32 v166, v58, v58
  v_mfma_f32_16x16x32_bf16 v[84:87], v[32:35], a[76:79], v[84:87]
  s_waitcnt lgkmcnt(4)
  buffer_load_dwordx4 v1, s[4:7], s48 offen lds
  v_mfma_f32_16x16x32_bf16 v[88:91], v[36:39], a[72:75], v[88:91]
  ds_read_b128 v[24:27], v1 offset:22528
  v_mul_f32 v167, v59, v59
  v_mfma_f32_16x16x32_bf16 v[92:95], v[36:39], a[76:79], v[92:95]
  s_waitcnt lgkmcnt(4)
  v_fma_f32 v164, v164, v178, v176
  v_fma_f32 v165, v165, v178, v176
  v_mfma_f32_16x16x32_bf16 v[96:99], v[40:43], a[72:75], v[96:99]
  ds_read_b128 v[28:31], v1 offset:23552
  v_fma_f32 v166, v166, v178, v176
  v_mfma_f32_16x16x32_bf16 v[100:103], v[40:43], a[76:79], v[100:103]
  s_waitcnt lgkmcnt(4)
  buffer_load_dwordx4 v1, s[4:7], s48 offen offset:1024 lds
  v_mfma_f32_16x16x32_bf16 v[104:107], v[44:47], a[72:75], v[104:107]
  ds_read_b128 v[32:35], v1 offset:24576
  v_fma_f32 v167, v167, v178, v176
  v_mfma_f32_16x16x32_bf16 v[108:111], v[44:47], a[76:79], v[108:111]
  s_waitcnt lgkmcnt(4)
  v_mul_f32 v164, v164, v56
  v_mul_f32 v165, v165, v57
  s_waitcnt vmcnt(21)
  s_barrier
  v_mfma_f32_16x16x32_bf16 v[80:83], v[16:19], a[80:83], v[80:83]
  ds_read_b128 v[36:39], v1 offset:25600
  v_mul_f32 v166, v166, v58
  v_mfma_f32_16x16x32_bf16 v[84:87], v[16:19], a[84:87], v[84:87]
  s_waitcnt lgkmcnt(4)
  buffer_load_dwordx4 v1, s[4:7], s48 offen offset:2048 lds
  v_mfma_f32_16x16x32_bf16 v[88:91], v[20:23], a[80:83], v[88:91]
  ds_read_b128 v[40:43], v1 offset:26624
  v_mul_f32 v167, v167, v59
  v_mfma_f32_16x16x32_bf16 v[92:95], v[20:23], a[84:87], v[92:95]
  s_waitcnt lgkmcnt(4)
  v_exp_f32 v164, v164
  v_mfma_f32_16x16x32_bf16 v[96:99], v[24:27], a[80:83], v[96:99]
  ds_read_b128 v[44:47], v1 offset:27648
  v_mul_f32 v156, v56, v72
  v_mfma_f32_16x16x32_bf16 v[100:103], v[24:27], a[84:87], v[100:103]
  s_waitcnt lgkmcnt(4)
  buffer_load_dwordx4 v1, s[4:7], s48 offen offset:3072 lds
  v_mfma_f32_16x16x32_bf16 v[104:107], v[28:31], a[80:83], v[104:107]
  ds_read_b128 v[16:19], v1 offset:28672
  s_add_u32 m0, s21, 126976
  v_mfma_f32_16x16x32_bf16 v[108:111], v[28:31], a[84:87], v[108:111]
  s_waitcnt lgkmcnt(4)
  s_add_u32 s48, s25, 4096
  v_mfma_f32_16x16x32_bf16 v[80:83], v[32:35], a[88:91], v[80:83]
  ds_read_b128 v[20:23], v1 offset:29696
  v_mfma_f32_16x16x32_bf16 v[84:87], v[32:35], a[92:95], v[84:87]
  s_waitcnt lgkmcnt(4)
  buffer_load_dwordx4 v1, s[4:7], s48 offen lds
  v_mfma_f32_16x16x32_bf16 v[88:91], v[36:39], a[88:91], v[88:91]
  ds_read_b128 v[24:27], v1 offset:30720
  s_add_u32 m0, s21, 0
  v_mfma_f32_16x16x32_bf16 v[92:95], v[36:39], a[92:95], v[92:95]
  s_waitcnt lgkmcnt(4)
  s_add_u32 s48, s24, 225280
  v_mfma_f32_16x16x32_bf16 v[96:99], v[40:43], a[88:91], v[96:99]
  ds_read_b128 v[28:31], v1 offset:31744
  v_mfma_f32_16x16x32_bf16 v[100:103], v[40:43], a[92:95], v[100:103]
  s_waitcnt lgkmcnt(4)
  buffer_load_dwordx4 v1, s[4:7], s48 offen lds
  v_mfma_f32_16x16x32_bf16 v[104:107], v[44:47], a[88:91], v[104:107]
  ds_read_b128 v[32:35], v1 offset:32768
  v_mfma_f32_16x16x32_bf16 v[108:111], v[44:47], a[92:95], v[108:111]
  s_waitcnt lgkmcnt(4)
  v_exp_f32 v165, v165
  v_mfma_f32_16x16x32_bf16 v[80:83], v[16:19], a[96:99], v[80:83]
  ds_read_b128 v[36:39], v1 offset:33792
  v_mul_f32 v157, v57, v73
  v_mfma_f32_16x16x32_bf16 v[84:87], v[16:19], a[100:103], v[84:87]
  s_waitcnt lgkmcnt(4)
  buffer_load_dwordx4 v1, s[4:7], s48 offen offset:1024 lds
  v_mfma_f32_16x16x32_bf16 v[88:91], v[20:23], a[96:99], v[88:91]
  ds_read_b128 v[40:43], v1 offset:34816
  v_mfma_f32_16x16x32_bf16 v[92:95], v[20:23], a[100:103], v[92:95]
  s_waitcnt lgkmcnt(4)
  v_exp_f32 v166, v166
  v_mfma_f32_16x16x32_bf16 v[96:99], v[24:27], a[96:99], v[96:99]
  ds_read_b128 v[44:47], v1 offset:35840
  v_mul_f32 v158, v58, v74
  v_mfma_f32_16x16x32_bf16 v[100:103], v[24:27], a[100:103], v[100:103]
  s_waitcnt lgkmcnt(4)
  buffer_load_dwordx4 v1, s[4:7], s48 offen offset:2048 lds
  v_mfma_f32_16x16x32_bf16 v[104:107], v[28:31], a[96:99], v[104:107]
  ds_read_b128 v[16:19], v1 offset:36864
  v_mfma_f32_16x16x32_bf16 v[108:111], v[28:31], a[100:103], v[108:111]
  s_waitcnt lgkmcnt(4)
  v_exp_f32 v167, v167
  v_mfma_f32_16x16x32_bf16 v[80:83], v[32:35], a[104:107], v[80:83]
  ds_read_b128 v[20:23], v1 offset:37888
  v_mul_f32 v159, v59, v75
  v_mfma_f32_16x16x32_bf16 v[84:87], v[32:35], a[108:111], v[84:87]
  s_waitcnt lgkmcnt(4)
  buffer_load_dwordx4 v1, s[4:7], s48 offen offset:3072 lds
  v_mfma_f32_16x16x32_bf16 v[88:91], v[36:39], a[104:107], v[88:91]
  ds_read_b128 v[24:27], v1 offset:38912
  s_add_u32 m0, s21, 4096
  v_mfma_f32_16x16x32_bf16 v[92:95], v[36:39], a[108:111], v[92:95]
  s_waitcnt lgkmcnt(4)
  s_add_u32 s48, s24, 229376
  v_fma_f32 v164, v164, v122, v122
  v_mfma_f32_16x16x32_bf16 v[96:99], v[40:43], a[104:107], v[96:99]
  ds_read_b128 v[28:31], v1 offset:39936
  v_fma_f32 v165, v165, v122, v122
  v_mfma_f32_16x16x32_bf16 v[100:103], v[40:43], a[108:111], v[100:103]
  s_waitcnt lgkmcnt(4)
  buffer_load_dwordx4 v1, s[4:7], s48 offen lds
  v_mfma_f32_16x16x32_bf16 v[104:107], v[44:47], a[104:107], v[104:107]
  ds_read_b128 v[32:35], v1 offset:40960
  s_add_u32 m0, s21, 143360
  v_mfma_f32_16x16x32_bf16 v[108:111], v[44:47], a[108:111], v[108:111]
  s_waitcnt lgkmcnt(4)
  s_add_u32 s48, s25, 20480
  v_fma_f32 v166, v166, v122, v122
  v_mfma_f32_16x16x32_bf16 v[80:83], v[16:19], a[112:115], v[80:83]
  ds_read_b128 v[36:39], v1 offset:41984
  v_fma_f32 v167, v167, v122, v122
  v_mfma_f32_16x16x32_bf16 v[84:87], v[16:19], a[116:119], v[84:87]
  s_waitcnt lgkmcnt(4)
  buffer_load_dwordx4 v1, s[4:7], s48 offen lds
  v_mfma_f32_16x16x32_bf16 v[88:91], v[20:23], a[112:115], v[88:91]
  ds_read_b128 v[40:43], v1 offset:43008
  v_mfma_f32_16x16x32_bf16 v[92:95], v[20:23], a[116:119], v[92:95]
  s_waitcnt lgkmcnt(4)
  v_rcp_f32 v164, v164
  v_mfma_f32_16x16x32_bf16 v[96:99], v[24:27], a[112:115], v[96:99]
  ds_read_b128 v[44:47], v1 offset:44032
  v_mfma_f32_16x16x32_bf16 v[100:103], v[24:27], a[116:119], v[100:103]
  s_waitcnt lgkmcnt(4)
  buffer_load_dwordx4 v1, s[4:7], s48 offen offset:1024 lds
  v_mfma_f32_16x16x32_bf16 v[104:107], v[28:31], a[112:115], v[104:107]
  ds_read_b128 v[16:19], v1 offset:45056
  v_mfma_f32_16x16x32_bf16 v[108:111], v[28:31], a[116:119], v[108:111]
  s_waitcnt lgkmcnt(4)
  v_rcp_f32 v165, v165
  s_waitcnt vmcnt(26)
  s_barrier
  v_mfma_f32_16x16x32_bf16 v[80:83], v[32:35], a[120:123], v[80:83]
  ds_read_b128 v[20:23], v1 offset:46080
  v_mfma_f32_16x16x32_bf16 v[84:87], v[32:35], a[124:127], v[84:87]
  s_waitcnt lgkmcnt(4)
  buffer_load_dwordx4 v1, s[4:7], s48 offen offset:2048 lds
  v_mfma_f32_16x16x32_bf16 v[88:91], v[36:39], a[120:123], v[88:91]
  ds_read_b128 v[24:27], v1 offset:47104
  v_mfma_f32_16x16x32_bf16 v[92:95], v[36:39], a[124:127], v[92:95]
  s_waitcnt lgkmcnt(4)
  v_rcp_f32 v166, v166
  v_mfma_f32_16x16x32_bf16 v[96:99], v[40:43], a[120:123], v[96:99]
  ds_read_b128 v[28:31], v1 offset:48128
  v_mfma_f32_16x16x32_bf16 v[100:103], v[40:43], a[124:127], v[100:103]
  s_waitcnt lgkmcnt(4)
  buffer_load_dwordx4 v1, s[4:7], s48 offen offset:3072 lds
  v_mfma_f32_16x16x32_bf16 v[104:107], v[44:47], a[120:123], v[104:107]
  ds_read_b128 v[32:35], v1 offset:49152
  s_add_u32 m0, s21, 147456
  v_mfma_f32_16x16x32_bf16 v[108:111], v[44:47], a[124:127], v[108:111]
  s_waitcnt lgkmcnt(4)
  s_add_u32 s48, s25, 24576
  v_mfma_f32_16x16x32_bf16 v[80:83], v[16:19], a[128:131], v[80:83]
  ds_read_b128 v[36:39], v1 offset:50176
  v_mfma_f32_16x16x32_bf16 v[84:87], v[16:19], a[132:135], v[84:87]
  s_waitcnt lgkmcnt(4)
  buffer_load_dwordx4 v1, s[4:7], s48 offen lds
  v_mfma_f32_16x16x32_bf16 v[88:91], v[20:23], a[128:131], v[88:91]
  ds_read_b128 v[40:43], v1 offset:51200
  s_add_u32 m0, s21, 20480
  v_mfma_f32_16x16x32_bf16 v[92:95], v[20:23], a[132:135], v[92:95]
  s_waitcnt lgkmcnt(4)
  s_add_u32 s48, s25, 40960
  v_mfma_f32_16x16x32_bf16 v[96:99], v[24:27], a[128:131], v[96:99]
  ds_read_b128 v[44:47], v1 offset:52224
  v_mfma_f32_16x16x32_bf16 v[100:103], v[24:27], a[132:135], v[100:103]
  s_waitcnt lgkmcnt(4)
  buffer_load_dwordx4 v1, s[4:7], s48 offen lds
  v_mfma_f32_16x16x32_bf16 v[104:107], v[28:31], a[128:131], v[104:107]
  ds_read_b128 v[16:19], v1 offset:53248
  v_mfma_f32_16x16x32_bf16 v[108:111], v[28:31], a[132:135], v[108:111]
  s_waitcnt lgkmcnt(4)
  v_rcp_f32 v167, v167
  v_mfma_f32_16x16x32_bf16 v[80:83], v[32:35], a[136:139], v[80:83]
  ds_read_b128 v[20:23], v1 offset:54272
  v_mul_f32 v156, v156, v164
  v_mfma_f32_16x16x32_bf16 v[84:87], v[32:35], a[140:143], v[84:87]
  s_waitcnt lgkmcnt(4)
  buffer_load_dwordx4 v1, s[4:7], s48 offen offset:1024 lds
  v_mfma_f32_16x16x32_bf16 v[88:91], v[36:39], a[136:139], v[88:91]
  ds_read_b128 v[24:27], v1 offset:55296
  v_mul_f32 v157, v157, v165
  v_mfma_f32_16x16x32_bf16 v[92:95], v[36:39], a[140:143], v[92:95]
  s_waitcnt lgkmcnt(4)
  v_mul_f32 v158, v158, v166
  v_mul_f32 v159, v159, v167
  v_mfma_f32_16x16x32_bf16 v[96:99], v[40:43], a[136:139], v[96:99]
  ds_read_b128 v[28:31], v1 offset:56320
  v_cvt_pk_bf16_f32 v170, v156, v157
  v_mfma_f32_16x16x32_bf16 v[100:103], v[40:43], a[140:143], v[100:103]
  s_waitcnt lgkmcnt(4)
  buffer_load_dwordx4 v1, s[4:7], s48 offen offset:2048 lds
  v_mfma_f32_16x16x32_bf16 v[104:107], v[44:47], a[136:139], v[104:107]
  ds_read_b128 v[32:35], v1 offset:57344
  v_cvt_pk_bf16_f32 v171, v158, v159
  v_mfma_f32_16x16x32_bf16 v[108:111], v[44:47], a[140:143], v[108:111]
  s_waitcnt lgkmcnt(4)
  s_add_u32 s31, s49, 0
  v_mfma_f32_16x16x32_bf16 v[80:83], v[16:19], a[144:147], v[80:83]
  ds_read_b128 v[36:39], v1 offset:58368
  v_mfma_f32_16x16x32_bf16 v[84:87], v[16:19], a[148:151], v[84:87]
  s_waitcnt lgkmcnt(4)
  buffer_load_dwordx4 v1, s[4:7], s48 offen offset:3072 lds
  v_mfma_f32_16x16x32_bf16 v[88:91], v[20:23], a[144:147], v[88:91]
  ds_read_b128 v[40:43], v1 offset:59392
  s_add_u32 m0, s21, 24576
  v_mfma_f32_16x16x32_bf16 v[92:95], v[20:23], a[148:151], v[92:95]
  s_waitcnt lgkmcnt(4)
  s_add_u32 s48, s25, 45056
  v_mfma_f32_16x16x32_bf16 v[96:99], v[24:27], a[144:147], v[96:99]
  ds_read_b128 v[44:47], v1 offset:60416
  v_mfma_f32_16x16x32_bf16 v[100:103], v[24:27], a[148:151], v[100:103]
  s_waitcnt lgkmcnt(4)
  buffer_load_dwordx4 v1, s[4:7], s48 offen lds
  v_mfma_f32_16x16x32_bf16 v[104:107], v[28:31], a[144:147], v[104:107]
  ds_read_b128 v[16:19], v7 offset:0
  v_mfma_f32_16x16x32_bf16 v[108:111], v[28:31], a[148:151], v[108:111]
  s_waitcnt lgkmcnt(4)
  v_mfma_f32_16x16x32_bf16 v[80:83], v[32:35], a[152:155], v[80:83]
  ds_read_b128 v[20:23], v7 offset:1024
  v_mfma_f32_16x16x32_bf16 v[84:87], v[32:35], a[156:159], v[84:87]
  s_waitcnt lgkmcnt(4)
  buffer_store_dwordx4 v[168:171], v1, s[4:7], s31 offen sc1
  v_mfma_f32_16x16x32_bf16 v[88:91], v[36:39], a[152:155], v[88:91]
  ds_read_b128 v[24:27], v7 offset:2048
  v_mul_f32 v160, v52, v52
  v_mfma_f32_16x16x32_bf16 v[92:95], v[36:39], a[156:159], v[92:95]
  s_waitcnt lgkmcnt(4)
  v_mul_f32 v161, v53, v53
  v_mul_f32 v162, v54, v54
  v_mfma_f32_16x16x32_bf16 v[96:99], v[40:43], a[152:155], v[96:99]
  ds_read_b128 v[28:31], v7 offset:3072
  v_mul_f32 v163, v55, v55
  v_mfma_f32_16x16x32_bf16 v[100:103], v[40:43], a[156:159], v[100:103]
  s_waitcnt lgkmcnt(4)
  v_fma_f32 v160, v160, v179, v177
  v_fma_f32 v161, v161, v179, v177
  v_mfma_f32_16x16x32_bf16 v[104:107], v[44:47], a[152:155], v[104:107]
  ds_read_b128 v[32:35], v7 offset:4096
  v_fma_f32 v162, v162, v179, v177
  v_mfma_f32_16x16x32_bf16 v[108:111], v[44:47], a[156:159], v[108:111]
  s_waitcnt lgkmcnt(4)
  v_fma_f32 v163, v163, v179, v177
  v_mul_f32 v160, v160, v52
  v_mul_f32 v161, v161, v53
  v_mul_f32 v162, v162, v54
  v_mul_f32 v163, v163, v55
  v_exp_f32 v160, v160
  v_mul_f32 v152, v52, v68
  v_exp_f32 v161, v161
  v_mul_f32 v153, v53, v69
  v_exp_f32 v162, v162
  v_mul_f32 v154, v54, v70
  v_exp_f32 v163, v163
  v_mul_f32 v155, v55, v71
  v_fma_f32 v160, v160, v123, v123
  v_fma_f32 v161, v161, v123, v123
  v_fma_f32 v162, v162, v123, v123
  v_fma_f32 v163, v163, v123, v123
  v_rcp_f32 v160, v160
  v_rcp_f32 v161, v161
  v_rcp_f32 v162, v162
  v_rcp_f32 v163, v163
  v_mul_f32 v152, v152, v160
  v_mul_f32 v153, v153, v161
  v_mul_f32 v154, v154, v162
  v_mul_f32 v155, v155, v163
  v_cvt_pk_bf16_f32 v172, v152, v153
  v_cvt_pk_bf16_f32 v173, v154, v155
  v_mul_f32 v164, v60, v60
  v_mul_f32 v165, v61, v61
  v_mul_f32 v166, v62, v62
  v_mul_f32 v167, v63, v63
  v_fma_f32 v164, v164, v179, v177
  v_fma_f32 v165, v165, v179, v177
  v_fma_f32 v166, v166, v179, v177
  v_fma_f32 v167, v167, v179, v177
  v_mul_f32 v164, v164, v60
  v_mul_f32 v165, v165, v61
  v_mul_f32 v166, v166, v62
  v_mul_f32 v167, v167, v63
  v_exp_f32 v164, v164
  v_mul_f32 v156, v60, v76
  v_exp_f32 v165, v165
  v_mul_f32 v157, v61, v77
  v_exp_f32 v166, v166
  v_mul_f32 v158, v62, v78
  v_exp_f32 v167, v167
  v_mul_f32 v159, v63, v79
  v_fma_f32 v164, v164, v123, v123
  v_fma_f32 v165, v165, v123, v123
  v_fma_f32 v166, v166, v123, v123
  v_fma_f32 v167, v167, v123, v123
  v_rcp_f32 v164, v164
  v_rcp_f32 v165, v165
  v_rcp_f32 v166, v166
  v_rcp_f32 v167, v167
  v_mul_f32 v156, v156, v164
  v_mul_f32 v157, v157, v165
  v_mul_f32 v158, v158, v166
  v_mul_f32 v159, v159, v167
  v_cvt_pk_bf16_f32 v174, v156, v157
  v_cvt_pk_bf16_f32 v175, v158, v159
  s_add_u32 s31, s49, 49152
  buffer_store_dwordx4 v[172:175], v1, s[4:7], s31 offen sc1
  s_waitcnt vmcnt(31)
  s_barrier
  s_waitcnt vmcnt(30)
  v_mfma_f32_16x16x32_bf16 v[80:83], v[136:139], v[124:127], v[80:83]
  s_add_u32 m0, s21, 40960
  s_add_u32 s48, s25, 61440
  v_mfma_f32_16x16x32_bf16 v[84:87], v[136:139], v[132:135], v[84:87]
  buffer_load_dwordx4 v1, s[4:7], s48 offen lds
  s_waitcnt vmcnt(30)
  v_mfma_f32_16x16x32_bf16 v[88:91], v[140:143], v[124:127], v[88:91]
  v_mfma_f32_16x16x32_bf16 v[92:95], v[140:143], v[132:135], v[92:95]
  s_waitcnt vmcnt(29)
  v_mfma_f32_16x16x32_bf16 v[96:99], v[144:147], v[124:127], v[96:99]
  v_mfma_f32_16x16x32_bf16 v[100:103], v[144:147], v[132:135], v[100:103]
  buffer_load_dwordx4 v1, s[4:7], s48 offen offset:1024 lds
  s_waitcnt vmcnt(29)
  v_mfma_f32_16x16x32_bf16 v[104:107], v[148:151], v[124:127], v[104:107]
  v_mfma_f32_16x16x32_bf16 v[108:111], v[148:151], v[132:135], v[108:111]
  v_mfma_f32_16x16x32_bf16 v[48:51], v[16:19], a[0:3], 0
  ds_read_b128 v[36:39], v7 offset:5120
  v_mfma_f32_16x16x32_bf16 v[52:55], v[16:19], a[4:7], 0
  s_waitcnt lgkmcnt(4)
  buffer_load_dwordx4 v1, s[4:7], s48 offen offset:2048 lds
  v_mfma_f32_16x16x32_bf16 v[56:59], v[20:23], a[0:3], 0
  ds_read_b128 v[40:43], v7 offset:6144
  v_mul_f32 v160, v80, v80
  v_mfma_f32_16x16x32_bf16 v[60:63], v[20:23], a[4:7], 0
  s_waitcnt lgkmcnt(4)
  v_mul_f32 v161, v81, v81
  v_mul_f32 v162, v82, v82
  v_mfma_f32_16x16x32_bf16 v[64:67], v[24:27], a[0:3], 0
  ds_read_b128 v[44:47], v7 offset:7168
  v_mul_f32 v163, v83, v83
  v_mfma_f32_16x16x32_bf16 v[68:71], v[24:27], a[4:7], 0
  s_waitcnt lgkmcnt(4)
  buffer_load_dwordx4 v1, s[4:7], s48 offen offset:3072 lds
  v_mfma_f32_16x16x32_bf16 v[72:75], v[28:31], a[0:3], 0
  ds_read_b128 v[16:19], v7 offset:8192
  s_add_u32 m0, s21, 45056
  v_mfma_f32_16x16x32_bf16 v[76:79], v[28:31], a[4:7], 0
  s_waitcnt lgkmcnt(4)
  s_add_u32 s48, s25, 65536
  v_fma_f32 v160, v160, v178, v176
  v_mfma_f32_16x16x32_bf16 v[48:51], v[32:35], a[8:11], v[48:51]
  ds_read_b128 v[20:23], v7 offset:9216
  v_fma_f32 v161, v161, v178, v176
  v_mfma_f32_16x16x32_bf16 v[52:55], v[32:35], a[12:15], v[52:55]
  s_waitcnt lgkmcnt(4)
  buffer_load_dwordx4 v1, s[4:7], s48 offen lds
  v_mfma_f32_16x16x32_bf16 v[56:59], v[36:39], a[8:11], v[56:59]
  ds_read_b128 v[24:27], v7 offset:10240
  s_add_u32 s30, s30, 4096
  v_mfma_f32_16x16x32_bf16 v[60:63], v[36:39], a[12:15], v[60:63]
  s_waitcnt lgkmcnt(4)
  v_fma_f32 v162, v162, v178, v176
  v_fma_f32 v163, v163, v178, v176
  v_mfma_f32_16x16x32_bf16 v[64:67], v[40:43], a[8:11], v[64:67]
  ds_read_b128 v[28:31], v7 offset:11264
  v_mul_f32 v160, v160, v80
  v_mfma_f32_16x16x32_bf16 v[68:71], v[40:43], a[12:15], v[68:71]
  s_waitcnt lgkmcnt(4)
  buffer_load_dwordx4 v[136:139], v1, s[4:7], s30 offen offset:0
  v_mfma_f32_16x16x32_bf16 v[72:75], v[44:47], a[8:11], v[72:75]
  ds_read_b128 v[32:35], v7 offset:12288
  v_mul_f32 v161, v161, v81
  v_mfma_f32_16x16x32_bf16 v[76:79], v[44:47], a[12:15], v[76:79]
  s_waitcnt lgkmcnt(4)
  v_mul_f32 v162, v162, v82
  v_mul_f32 v163, v163, v83
  v_mfma_f32_16x16x32_bf16 v[48:51], v[16:19], a[16:19], v[48:51]
  ds_read_b128 v[36:39], v7 offset:13312
  v_mfma_f32_16x16x32_bf16 v[52:55], v[16:19], a[20:23], v[52:55]
  s_waitcnt lgkmcnt(4)
  buffer_load_dwordx4 v[140:143], v1, s[4:7], s30 offen offset:1024
  v_mfma_f32_16x16x32_bf16 v[56:59], v[20:23], a[16:19], v[56:59]
  ds_read_b128 v[40:43], v7 offset:14336
  v_mfma_f32_16x16x32_bf16 v[60:63], v[20:23], a[20:23], v[60:63]
  s_waitcnt lgkmcnt(4)
  v_exp_f32 v160, v160
  v_mfma_f32_16x16x32_bf16 v[64:67], v[24:27], a[16:19], v[64:67]
  ds_read_b128 v[44:47], v7 offset:15360
  v_mul_f32 v152, v80, v96
  v_mfma_f32_16x16x32_bf16 v[68:71], v[24:27], a[20:23], v[68:71]
  s_waitcnt lgkmcnt(4)
  buffer_load_dwordx4 v[144:147], v1, s[4:7], s30 offen offset:2048
  v_mfma_f32_16x16x32_bf16 v[72:75], v[28:31], a[16:19], v[72:75]
  ds_read_b128 v[16:19], v7 offset:16384
  v_mfma_f32_16x16x32_bf16 v[76:79], v[28:31], a[20:23], v[76:79]
  s_waitcnt lgkmcnt(4)
  v_exp_f32 v161, v161
  v_mfma_f32_16x16x32_bf16 v[48:51], v[32:35], a[24:27], v[48:51]
  ds_read_b128 v[20:23], v7 offset:17408
  v_mul_f32 v153, v81, v97
  v_mfma_f32_16x16x32_bf16 v[52:55], v[32:35], a[28:31], v[52:55]
  s_waitcnt lgkmcnt(4)
  buffer_load_dwordx4 v[148:151], v1, s[4:7], s30 offen offset:3072
  v_mfma_f32_16x16x32_bf16 v[56:59], v[36:39], a[24:27], v[56:59]
  ds_read_b128 v[24:27], v7 offset:18432
  v_mfma_f32_16x16x32_bf16 v[60:63], v[36:39], a[28:31], v[60:63]
  s_waitcnt lgkmcnt(4)
  v_exp_f32 v162, v162
  v_mfma_f32_16x16x32_bf16 v[64:67], v[40:43], a[24:27], v[64:67]
  ds_read_b128 v[28:31], v7 offset:19456
  v_mul_f32 v154, v82, v98
  v_mfma_f32_16x16x32_bf16 v[68:71], v[40:43], a[28:31], v[68:71]
  s_waitcnt lgkmcnt(4)
  v_exp_f32 v163, v163
  v_mfma_f32_16x16x32_bf16 v[72:75], v[44:47], a[24:27], v[72:75]
  ds_read_b128 v[32:35], v7 offset:20480
  v_mul_f32 v155, v83, v99
  v_mfma_f32_16x16x32_bf16 v[76:79], v[44:47], a[28:31], v[76:79]
  s_waitcnt lgkmcnt(4)
  v_fma_f32 v160, v160, v122, v122
  v_fma_f32 v161, v161, v122, v122
  v_mfma_f32_16x16x32_bf16 v[48:51], v[16:19], a[32:35], v[48:51]
  ds_read_b128 v[36:39], v7 offset:21504
  v_fma_f32 v162, v162, v122, v122
  v_mfma_f32_16x16x32_bf16 v[52:55], v[16:19], a[36:39], v[52:55]
  s_waitcnt lgkmcnt(4)
  v_fma_f32 v163, v163, v122, v122
  v_mfma_f32_16x16x32_bf16 v[56:59], v[20:23], a[32:35], v[56:59]
  ds_read_b128 v[40:43], v7 offset:22528
  v_mfma_f32_16x16x32_bf16 v[60:63], v[20:23], a[36:39], v[60:63]
  s_waitcnt lgkmcnt(4)
  v_rcp_f32 v160, v160
  v_mfma_f32_16x16x32_bf16 v[64:67], v[24:27], a[32:35], v[64:67]
  ds_read_b128 v[44:47], v7 offset:23552
  v_mfma_f32_16x16x32_bf16 v[68:71], v[24:27], a[36:39], v[68:71]
  s_waitcnt lgkmcnt(4)
  v_rcp_f32 v161, v161
  v_mfma_f32_16x16x32_bf16 v[72:75], v[28:31], a[32:35], v[72:75]
  ds_read_b128 v[16:19], v7 offset:24576
  v_mfma_f32_16x16x32_bf16 v[76:79], v[28:31], a[36:39], v[76:79]
  s_waitcnt lgkmcnt(4)
  v_rcp_f32 v162, v162
  s_waitcnt vmcnt(31)
  s_waitcnt vmcnt(9)
  s_barrier
  s_cmp_lg_u32 s16, 0
  s_cbranch_scc1 M_sig_1018
  s_mov_b64 exec, 1
  buffer_atomic_add v5, v4, s[4:7], s26 offen sc1
  s_mov_b64 exec, -1
M_sig_1018:
  v_mfma_f32_16x16x32_bf16 v[48:51], v[32:35], a[40:43], v[48:51]
  ds_read_b128 v[20:23], v7 offset:25600
  s_add_u32 m0, s21, 61440
  v_mfma_f32_16x16x32_bf16 v[52:55], v[32:35], a[44:47], v[52:55]
  s_waitcnt lgkmcnt(4)
  s_add_u32 s48, s25, 81920
  v_mfma_f32_16x16x32_bf16 v[56:59], v[36:39], a[40:43], v[56:59]
  ds_read_b128 v[24:27], v7 offset:26624
  v_mfma_f32_16x16x32_bf16 v[60:63], v[36:39], a[44:47], v[60:63]
  s_waitcnt lgkmcnt(4)
  buffer_load_dwordx4 v1, s[4:7], s48 offen lds
  v_mfma_f32_16x16x32_bf16 v[64:67], v[40:43], a[40:43], v[64:67]
  ds_read_b128 v[28:31], v7 offset:27648
  v_mfma_f32_16x16x32_bf16 v[68:71], v[40:43], a[44:47], v[68:71]
  s_waitcnt lgkmcnt(4)
  v_rcp_f32 v163, v163
  v_mfma_f32_16x16x32_bf16 v[72:75], v[44:47], a[40:43], v[72:75]
  ds_read_b128 v[32:35], v7 offset:28672
  v_mul_f32 v152, v152, v160
  v_mfma_f32_16x16x32_bf16 v[76:79], v[44:47], a[44:47], v[76:79]
  s_waitcnt lgkmcnt(4)
  buffer_load_dwordx4 v1, s[4:7], s48 offen offset:1024 lds
  v_mfma_f32_16x16x32_bf16 v[48:51], v[16:19], a[48:51], v[48:51]
  ds_read_b128 v[36:39], v7 offset:29696
  v_mul_f32 v153, v153, v161
  v_mfma_f32_16x16x32_bf16 v[52:55], v[16:19], a[52:55], v[52:55]
  s_waitcnt lgkmcnt(4)
  v_mul_f32 v154, v154, v162
  v_mul_f32 v155, v155, v163
  v_mfma_f32_16x16x32_bf16 v[56:59], v[20:23], a[48:51], v[56:59]
  ds_read_b128 v[40:43], v7 offset:30720
  v_cvt_pk_bf16_f32 v168, v152, v153
  v_mfma_f32_16x16x32_bf16 v[60:63], v[20:23], a[52:55], v[60:63]
  s_waitcnt lgkmcnt(4)
  buffer_load_dwordx4 v1, s[4:7], s48 offen offset:2048 lds
  v_mfma_f32_16x16x32_bf16 v[64:67], v[24:27], a[48:51], v[64:67]
  ds_read_b128 v[44:47], v7 offset:31744
  v_cvt_pk_bf16_f32 v169, v154, v155
  v_mfma_f32_16x16x32_bf16 v[68:71], v[24:27], a[52:55], v[68:71]
  s_waitcnt lgkmcnt(4)
  v_mul_f32 v164, v88, v88
  v_mul_f32 v165, v89, v89
  v_mfma_f32_16x16x32_bf16 v[72:75], v[28:31], a[48:51], v[72:75]
  ds_read_b128 v[16:19], v7 offset:32768
  v_mul_f32 v166, v90, v90
  v_mfma_f32_16x16x32_bf16 v[76:79], v[28:31], a[52:55], v[76:79]
  s_waitcnt lgkmcnt(4)
  buffer_load_dwordx4 v1, s[4:7], s48 offen offset:3072 lds
  v_mfma_f32_16x16x32_bf16 v[48:51], v[32:35], a[56:59], v[48:51]
  ds_read_b128 v[20:23], v7 offset:33792
  s_add_u32 m0, s21, 65536
  v_mfma_f32_16x16x32_bf16 v[52:55], v[32:35], a[60:63], v[52:55]
  s_waitcnt lgkmcnt(4)
  s_add_u32 s48, s25, 86016
  v_mul_f32 v167, v91, v91
  v_mfma_f32_16x16x32_bf16 v[56:59], v[36:39], a[56:59], v[56:59]
  ds_read_b128 v[24:27], v7 offset:34816
  v_fma_f32 v164, v164, v178, v176
  v_mfma_f32_16x16x32_bf16 v[60:63], v[36:39], a[60:63], v[60:63]
  s_waitcnt lgkmcnt(4)
  buffer_load_dwordx4 v1, s[4:7], s48 offen lds
  v_mfma_f32_16x16x32_bf16 v[64:67], v[40:43], a[56:59], v[64:67]
  ds_read_b128 v[28:31], v7 offset:35840
  v_fma_f32 v165, v165, v178, v176
  v_mfma_f32_16x16x32_bf16 v[68:71], v[40:43], a[60:63], v[68:71]
  s_waitcnt lgkmcnt(4)
  v_fma_f32 v166, v166, v178, v176
  v_fma_f32 v167, v167, v178, v176
  v_mfma_f32_16x16x32_bf16 v[72:75], v[44:47], a[56:59], v[72:75]
  ds_read_b128 v[32:35], v7 offset:36864
  v_mul_f32 v164, v164, v88
  v_mfma_f32_16x16x32_bf16 v[76:79], v[44:47], a[60:63], v[76:79]
  s_waitcnt lgkmcnt(4)
  buffer_load_dword v6, v4, s[4:7], s26 offen sc1
  v_mfma_f32_16x16x32_bf16 v[48:51], v[16:19], a[64:67], v[48:51]
  ds_read_b128 v[36:39], v7 offset:37888
  v_mul_f32 v165, v165, v89
  v_mfma_f32_16x16x32_bf16 v[52:55], v[16:19], a[68:71], v[52:55]
  s_waitcnt lgkmcnt(4)
  v_mul_f32 v166, v166, v90
  v_mul_f32 v167, v167, v91
  v_mfma_f32_16x16x32_bf16 v[56:59], v[20:23], a[64:67], v[56:59]
  ds_read_b128 v[40:43], v7 offset:38912
  v_mfma_f32_16x16x32_bf16 v[60:63], v[20:23], a[68:71], v[60:63]
  s_waitcnt lgkmcnt(4)
  v_exp_f32 v164, v164
  v_mfma_f32_16x16x32_bf16 v[64:67], v[24:27], a[64:67], v[64:67]
  ds_read_b128 v[44:47], v7 offset:39936
  v_mul_f32 v156, v88, v104
  v_mfma_f32_16x16x32_bf16 v[68:71], v[24:27], a[68:71], v[68:71]
  s_waitcnt lgkmcnt(4)
  v_exp_f32 v165, v165
  v_mfma_f32_16x16x32_bf16 v[72:75], v[28:31], a[64:67], v[72:75]
  ds_read_b128 v[16:19], v7 offset:40960
  v_mul_f32 v157, v89, v105
  v_mfma_f32_16x16x32_bf16 v[76:79], v[28:31], a[68:71], v[76:79]
  s_waitcnt lgkmcnt(4)
  v_exp_f32 v166, v166
  v_mfma_f32_16x16x32_bf16 v[48:51], v[32:35], a[72:75], v[48:51]
  ds_read_b128 v[20:23], v7 offset:41984
  v_mul_f32 v158, v90, v106
  v_mfma_f32_16x16x32_bf16 v[52:55], v[32:35], a[76:79], v[52:55]
  s_waitcnt lgkmcnt(4)
  v_exp_f32 v167, v167
  v_mfma_f32_16x16x32_bf16 v[56:59], v[36:39], a[72:75], v[56:59]
  ds_read_b128 v[24:27], v7 offset:43008
  v_mul_f32 v159, v91, v107
  v_mfma_f32_16x16x32_bf16 v[60:63], v[36:39], a[76:79], v[60:63]
  s_waitcnt lgkmcnt(4)
  v_fma_f32 v164, v164, v122, v122
  v_fma_f32 v165, v165, v122, v122
  v_mfma_f32_16x16x32_bf16 v[64:67], v[40:43], a[72:75], v[64:67]
  ds_read_b128 v[28:31], v7 offset:44032
  v_fma_f32 v166, v166, v122, v122
  v_mfma_f32_16x16x32_bf16 v[68:71], v[40:43], a[76:79], v[68:71]
  s_waitcnt lgkmcnt(4)
  v_fma_f32 v167, v167, v122, v122
  v_mfma_f32_16x16x32_bf16 v[72:75], v[44:47], a[72:75], v[72:75]
  ds_read_b128 v[32:35], v7 offset:45056
  v_mfma_f32_16x16x32_bf16 v[76:79], v[44:47], a[76:79], v[76:79]
  s_waitcnt lgkmcnt(4)
  v_rcp_f32 v164, v164
  s_barrier
  v_mfma_f32_16x16x32_bf16 v[48:51], v[16:19], a[80:83], v[48:51]
  ds_read_b128 v[36:39], v7 offset:46080
  v_mfma_f32_16x16x32_bf16 v[52:55], v[16:19], a[84:87], v[52:55]
  s_waitcnt lgkmcnt(4)
  v_rcp_f32 v165, v165
  v_mfma_f32_16x16x32_bf16 v[56:59], v[20:23], a[80:83], v[56:59]
  ds_read_b128 v[40:43], v7 offset:47104
  v_mfma_f32_16x16x32_bf16 v[60:63], v[20:23], a[84:87], v[60:63]
  s_waitcnt lgkmcnt(4)
  v_rcp_f32 v166, v166
  v_mfma_f32_16x16x32_bf16 v[64:67], v[24:27], a[80:83], v[64:67]
  ds_read_b128 v[44:47], v7 offset:48128
  v_mfma_f32_16x16x32_bf16 v[68:71], v[24:27], a[84:87], v[68:71]
  s_waitcnt lgkmcnt(4)
  v_rcp_f32 v167, v167
  v_mfma_f32_16x16x32_bf16 v[72:75], v[28:31], a[80:83], v[72:75]
  ds_read_b128 v[16:19], v7 offset:49152
  v_mul_f32 v156, v156, v164
  v_mfma_f32_16x16x32_bf16 v[76:79], v[28:31], a[84:87], v[76:79]
  s_waitcnt lgkmcnt(4)
  v_mul_f32 v157, v157, v165
  v_mul_f32 v158, v158, v166
  v_mfma_f32_16x16x32_bf16 v[48:51], v[32:35], a[88:91], v[48:51]
  ds_read_b128 v[20:23], v7 offset:50176
  v_mul_f32 v159, v159, v167
  v_mfma_f32_16x16x32_bf16 v[52:55], v[32:35], a[92:95], v[52:55]
  s_waitcnt lgkmcnt(4)
  v_cvt_pk_bf16_f32 v170, v156, v157
  v_cvt_pk_bf16_f32 v171, v158, v159
  v_mfma_f32_16x16x32_bf16 v[56:59], v[36:39], a[88:91], v[56:59]
  ds_read_b128 v[24:27], v7 offset:51200
  s_add_u32 s31, s49, 16384
  v_mfma_f32_16x16x32_bf16 v[60:63], v[36:39], a[92:95], v[60:63]
  s_waitcnt lgkmcnt(4)
  buffer_store_dwordx4 v[168:171], v1, s[4:7], s31 offen sc1
  s_waitcnt vmcnt(1)
  v_mov_b32 v6, v6
  v_cmp_gt_u32 vcc, 16, v6
  s_nop 4
  s_cbranch_vccz M_ck_18
  s_cmp_lg_u32 s40, 0
  s_cbranch_scc1 M_ck_18
  s_mov_b32 s41, 0
M_ckl_19:
  buffer_load_dword v6, v4, s[4:7], s26 offen sc1
  s_waitcnt vmcnt(0)
  v_cmp_gt_u32 vcc, 16, v6
  s_nop 4
  s_cbranch_vccz M_ck_18
  s_add_u32 s41, s41, 1
  s_cmp_lt_u32 s41, 40000
  s_cbranch_scc1 M_ckl_19
  s_mov_b32 s40, 1
M_ck_18:
  s_mul_i32 s50, s45, 48
  s_add_u32 s50, s50, s47
  s_lshl_b32 s50, s50, 10
  s_add_u32 s50, s50, s20
  s_add_u32 s50, s50, 0x7c0000
  s_mul_i32 s51, s46, 48
  s_add_u32 s51, s51, s47
  s_lshl_b32 s51, s51, 10
  s_add_u32 s51, s51, s20
  s_add_u32 s51, s51, 0x7c0000
  v_mfma_f32_16x16x32_bf16 v[64:67], v[40:43], a[88:91], v[64:67]
  ds_read_b128 v[28:31], v7 offset:52224
  s_add_u32 s52, s50, 0
  v_mfma_f32_16x16x32_bf16 v[68:71], v[40:43], a[92:95], v[68:71]
  s_waitcnt lgkmcnt(4)
  v_mul_f32 v160, v84, v84
  v_mul_f32 v161, v85, v85
  v_mfma_f32_16x16x32_bf16 v[72:75], v[44:47], a[88:91], v[72:75]
  ds_read_b128 v[32:35], v7 offset:53248
  v_mul_f32 v162, v86, v86
  v_mfma_f32_16x16x32_bf16 v[76:79], v[44:47], a[92:95], v[76:79]
  s_waitcnt lgkmcnt(4)
  buffer_load_dwordx4 a[160:163], v1, s[4:7], s52 offen offset:0 sc1
  v_mfma_f32_16x16x32_bf16 v[48:51], v[16:19], a[96:99], v[48:51]
  ds_read_b128 v[36:39], v7 offset:54272
  s_add_u32 s53, s51, 0
  v_mfma_f32_16x16x32_bf16 v[52:55], v[16:19], a[100:103], v[52:55]
  s_waitcnt lgkmcnt(4)
  v_mul_f32 v163, v87, v87
  v_fma_f32 v160, v160, v179, v177
  v_mfma_f32_16x16x32_bf16 v[56:59], v[20:23], a[96:99], v[56:59]
  ds_read_b128 v[40:43], v7 offset:55296
  v_fma_f32 v161, v161, v179, v177
  v_mfma_f32_16x16x32_bf16 v[60:63], v[20:23], a[100:103], v[60:63]
  s_waitcnt lgkmcnt(4)
  buffer_load_dwordx4 a[164:167], v1, s[4:7], s53 offen offset:0 sc1
  v_mfma_f32_16x16x32_bf16 v[64:67], v[24:27], a[96:99], v[64:67]
  ds_read_b128 v[44:47], v7 offset:56320
  v_fma_f32 v162, v162, v179, v177
  v_mfma_f32_16x16x32_bf16 v[68:71], v[24:27], a[100:103], v[68:71]
  s_waitcnt lgkmcnt(4)
  v_fma_f32 v163, v163, v179, v177
  v_mul_f32 v160, v160, v84
  v_mfma_f32_16x16x32_bf16 v[72:75], v[28:31], a[96:99], v[72:75]
  ds_read_b128 v[16:19], v7 offset:57344
  v_mul_f32 v161, v161, v85
  v_mfma_f32_16x16x32_bf16 v[76:79], v[28:31], a[100:103], v[76:79]
  s_waitcnt lgkmcnt(4)
  buffer_load_dwordx4 a[168:171], v1, s[4:7], s52 offen offset:2048 sc1
  v_mfma_f32_16x16x32_bf16 v[48:51], v[32:35], a[104:107], v[48:51]
  ds_read_b128 v[20:23], v7 offset:58368
  v_mul_f32 v162, v162, v86
  v_mfma_f32_16x16x32_bf16 v[52:55], v[32:35], a[108:111], v[52:55]
  s_waitcnt lgkmcnt(4)
  v_mul_f32 v163, v163, v87
  v_mfma_f32_16x16x32_bf16 v[56:59], v[36:39], a[104:107], v[56:59]
  ds_read_b128 v[24:27], v7 offset:59392
  v_mfma_f32_16x16x32_bf16 v[60:63], v[36:39], a[108:111], v[60:63]
  s_waitcnt lgkmcnt(4)
  buffer_load_dwordx4 a[172:175], v1, s[4:7], s53 offen offset:2048 sc1
  v_mfma_f32_16x16x32_bf16 v[64:67], v[40:43], a[104:107], v[64:67]
  ds_read_b128 v[28:31], v7 offset:60416
  s_add_u32 s52, s50, 4096
  v_mfma_f32_16x16x32_bf16 v[68:71], v[40:43], a[108:111], v[68:71]
  s_waitcnt lgkmcnt(4)
  v_exp_f32 v160, v160
  v_mfma_f32_16x16x32_bf16 v[72:75], v[44:47], a[104:107], v[72:75]
  ds_read_b128 v[32:35], v1 offset:0
  v_mul_f32 v152, v84, v100
  v_mfma_f32_16x16x32_bf16 v[76:79], v[44:47], a[108:111], v[76:79]
  s_waitcnt lgkmcnt(4)
  buffer_load_dwordx4 a[176:179], v1, s[4:7], s52 offen offset:0 sc1
  v_mfma_f32_16x16x32_bf16 v[48:51], v[16:19], a[112:115], v[48:51]
  ds_read_b128 v[36:39], v1 offset:1024
  s_add_u32 s53, s51, 4096
  v_mfma_f32_16x16x32_bf16 v[52:55], v[16:19], a[116:119], v[52:55]
  s_waitcnt lgkmcnt(4)
  v_exp_f32 v161, v161
  v_mfma_f32_16x16x32_bf16 v[56:59], v[20:23], a[112:115], v[56:59]
  ds_read_b128 v[40:43], v1 offset:2048
  v_mul_f32 v153, v85, v101
  v_mfma_f32_16x16x32_bf16 v[60:63], v[20:23], a[116:119], v[60:63]
  s_waitcnt lgkmcnt(4)
  buffer_load_dwordx4 a[180:183], v1, s[4:7], s53 offen offset:0 sc1
  v_mfma_f32_16x16x32_bf16 v[64:67], v[24:27], a[112:115], v[64:67]
  ds_read_b128 v[44:47], v1 offset:3072
  v_mfma_f32_16x16x32_bf16 v[68:71], v[24:27], a[116:119], v[68:71]
  s_waitcnt lgkmcnt(4)
  v_exp_f32 v162, v162
  v_mfma_f32_16x16x32_bf16 v[72:75], v[28:31], a[112:115], v[72:75]
  ds_read_b128 v[16:19], v1 offset:4096
  v_mul_f32 v154, v86, v102
  v_mfma_f32_16x16x32_bf16 v[76:79], v[28:31], a[116:119], v[76:79]
  s_waitcnt lgkmcnt(4)
  buffer_load_dwordx4 a[184:187], v1, s[4:7], s52 offen offset:2048 sc1
  s_barrier
  v_mfma_f32_16x16x32_bf16 v[48:51], v[32:35], a[120:123], v[48:51]
  ds_read_b128 v[20:23], v1 offset:5120
  v_mfma_f32_16x16x32_bf16 v[52:55], v[32:35], a[124:127], v[52:55]
  s_waitcnt lgkmcnt(4)
  v_exp_f32 v163, v163
  v_mfma_f32_16x16x32_bf16 v[56:59], v[36:39], a[120:123], v[56:59]
  ds_read_b128 v[24:27], v1 offset:6144
  v_mul_f32 v155, v87, v103
  v_mfma_f32_16x16x32_bf16 v[60:63], v[36:39], a[124:127], v[60:63]
  s_waitcnt lgkmcnt(4)
  buffer_load_dwordx4 a[188:191], v1, s[4:7], s53 offen offset:2048 sc1
  v_mfma_f32_16x16x32_bf16 v[64:67], v[40:43], a[120:123], v[64:67]
  ds_read_b128 v[28:31], v1 offset:7168
  s_add_u32 s52, s50, 8192
  v_mfma_f32_16x16x32_bf16 v[68:71], v[40:43], a[124:127], v[68:71]
  s_waitcnt lgkmcnt(4)
  v_fma_f32 v160, v160, v123, v123
  v_fma_f32 v161, v161, v123, v123
  v_mfma_f32_16x16x32_bf16 v[72:75], v[44:47], a[120:123], v[72:75]
  ds_read_b128 v[32:35], v1 offset:8192
  v_fma_f32 v162, v162, v123, v123
  v_mfma_f32_16x16x32_bf16 v[76:79], v[44:47], a[124:127], v[76:79]
  s_waitcnt lgkmcnt(4)
  buffer_load_dwordx4 a[192:195], v1, s[4:7], s52 offen offset:0 sc1
  v_mfma_f32_16x16x32_bf16 v[48:51], v[16:19], a[128:131], v[48:51]
  ds_read_b128 v[36:39], v1 offset:9216
  s_add_u32 s53, s51, 8192
  v_mfma_f32_16x16x32_bf16 v[52:55], v[16:19], a[132:135], v[52:55]
  s_waitcnt lgkmcnt(4)
  v_fma_f32 v163, v163, v123, v123
  v_mfma_f32_16x16x32_bf16 v[56:59], v[20:23], a[128:131], v[56:59]
  ds_read_b128 v[40:43], v1 offset:10240
  v_mfma_f32_16x16x32_bf16 v[60:63], v[20:23], a[132:135], v[60:63]
  s_waitcnt lgkmcnt(4)
  buffer_load_dwordx4 a[196:199], v1, s[4:7], s53 offen offset:0 sc1
  v_mfma_f32_16x16x32_bf16 v[64:67], v[24:27], a[128:131], v[64:67]
  ds_read_b128 v[44:47], v1 offset:11264
  v_mfma_f32_16x16x32_bf16 v[68:71], v[24:27], a[132:135], v[68:71]
  s_waitcnt lgkmcnt(4)
  v_rcp_f32 v160, v160
  v_mfma_f32_16x16x32_bf16 v[72:75], v[28:31], a[128:131], v[72:75]
  ds_read_b128 v[16:19], v1 offset:12288
  v_mfma_f32_16x16x32_bf16 v[76:79], v[28:31], a[132:135], v[76:79]
  s_waitcnt lgkmcnt(4)
  buffer_load_dwordx4 a[200:203], v1, s[4:7], s52 offen offset:2048 sc1
  v_mfma_f32_16x16x32_bf16 v[48:51], v[32:35], a[136:139], v[48:51]
  ds_read_b128 v[20:23], v1 offset:13312
  v_mfma_f32_16x16x32_bf16 v[52:55], v[32:35], a[140:143], v[52:55]
  s_waitcnt lgkmcnt(4)
  v_rcp_f32 v161, v161
  v_mfma_f32_16x16x32_bf16 v[56:59], v[36:39], a[136:139], v[56:59]
  ds_read_b128 v[24:27], v1 offset:14336
  v_mfma_f32_16x16x32_bf16 v[60:63], v[36:39], a[140:143], v[60:63]
  s_waitcnt lgkmcnt(4)
  buffer_load_dwordx4 a[204:207], v1, s[4:7], s53 offen offset:2048 sc1
  v_mfma_f32_16x16x32_bf16 v[64:67], v[40:43], a[136:139], v[64:67]
  ds_read_b128 v[28:31], v1 offset:15360
  s_add_u32 s52, s50, 12288
  v_mfma_f32_16x16x32_bf16 v[68:71], v[40:43], a[140:143], v[68:71]
  s_waitcnt lgkmcnt(4)
  v_rcp_f32 v162, v162
  v_mfma_f32_16x16x32_bf16 v[72:75], v[44:47], a[136:139], v[72:75]
  ds_read_b128 v[32:35], v1 offset:16384
  v_mfma_f32_16x16x32_bf16 v[76:79], v[44:47], a[140:143], v[76:79]
  s_waitcnt lgkmcnt(4)
  buffer_load_dwordx4 a[208:211], v1, s[4:7], s52 offen offset:0 sc1
  v_mfma_f32_16x16x32_bf16 v[48:51], v[16:19], a[144:147], v[48:51]
  ds_read_b128 v[36:39], v1 offset:17408
  s_add_u32 s53, s51, 12288
  v_mfma_f32_16x16x32_bf16 v[52:55], v[16:19], a[148:151], v[52:55]
  s_waitcnt lgkmcnt(4)
  v_rcp_f32 v163, v163
  v_mfma_f32_16x16x32_bf16 v[56:59], v[20:23], a[144:147], v[56:59]
  ds_read_b128 v[40:43], v1 offset:18432
  v_mul_f32 v152, v152, v160
  v_mfma_f32_16x16x32_bf16 v[60:63], v[20:23], a[148:151], v[60:63]
  s_waitcnt lgkmcnt(4)
  buffer_load_dwordx4 a[212:215], v1, s[4:7], s53 offen offset:0 sc1
  v_mfma_f32_16x16x32_bf16 v[64:67], v[24:27], a[144:147], v[64:67]
  ds_read_b128 v[44:47], v1 offset:19456
  v_mul_f32 v153, v153, v161
  v_mfma_f32_16x16x32_bf16 v[68:71], v[24:27], a[148:151], v[68:71]
  s_waitcnt lgkmcnt(4)
  v_mul_f32 v154, v154, v162
  v_mul_f32 v155, v155, v163
  v_mfma_f32_16x16x32_bf16 v[72:75], v[28:31], a[144:147], v[72:75]
  v_cvt_pk_bf16_f32 v172, v152, v153
  v_cvt_pk_bf16_f32 v173, v154, v155
  v_mfma_f32_16x16x32_bf16 v[76:79], v[28:31], a[148:151], v[76:79]
  s_waitcnt lgkmcnt(3)
  buffer_load_dwordx4 a[216:219], v1, s[4:7], s52 offen offset:2048 sc1
  v_mfma_f32_16x16x32_bf16 v[48:51], v[32:35], a[152:155], v[48:51]
  v_mul_f32 v164, v92, v92
  v_mul_f32 v165, v93, v93
  v_mfma_f32_16x16x32_bf16 v[52:55], v[32:35], a[156:159], v[52:55]
  s_waitcnt lgkmcnt(2)
  v_mul_f32 v166, v94, v94
  v_mul_f32 v167, v95, v95
  v_mfma_f32_16x16x32_bf16 v[56:59], v[36:39], a[152:155], v[56:59]
  v_fma_f32 v164, v164, v179, v177
  v_fma_f32 v165, v165, v179, v177
  v_mfma_f32_16x16x32_bf16 v[60:63], v[36:39], a[156:159], v[60:63]
  s_waitcnt lgkmcnt(1)
  buffer_load_dwordx4 a[220:223], v1, s[4:7], s53 offen offset:2048 sc1
  v_mfma_f32_16x16x32_bf16 v[64:67], v[40:43], a[152:155], v[64:67]
  v_fma_f32 v166, v166, v179, v177
  v_fma_f32 v167, v167, v179, v177
  v_mfma_f32_16x16x32_bf16 v[68:71], v[40:43], a[156:159], v[68:71]
  s_waitcnt lgkmcnt(0)
  v_mul_f32 v164, v164, v92
  v_mul_f32 v165, v165, v93
  v_mfma_f32_16x16x32_bf16 v[72:75], v[44:47], a[152:155], v[72:75]
  v_mul_f32 v166, v166, v94
  v_mul_f32 v167, v167, v95
  v_mfma_f32_16x16x32_bf16 v[76:79], v[44:47], a[156:159], v[76:79]
  v_exp_f32 v164, v164
  v_mul_f32 v156, v92, v108
  v_exp_f32 v165, v165
  v_mul_f32 v157, v93, v109
  v_exp_f32 v166, v166
  v_mul_f32 v158, v94, v110
  v_exp_f32 v167, v167
  v_mul_f32 v159, v95, v111
  v_fma_f32 v164, v164, v123, v123
  v_fma_f32 v165, v165, v123, v123
  v_fma_f32 v166, v166, v123, v123
  v_fma_f32 v167, v167, v123, v123
  v_rcp_f32 v164, v164
  v_rcp_f32 v165, v165
  v_rcp_f32 v166, v166
  v_rcp_f32 v167, v167
  v_mul_f32 v156, v156, v164
  v_mul_f32 v157, v157, v165
  v_mul_f32 v158, v158, v166
  v_mul_f32 v159, v159, v167
  v_cvt_pk_bf16_f32 v174, v156, v157
  v_cvt_pk_bf16_f32 v175, v158, v159
  s_add_u32 s31, s49, 65536
  buffer_store_dwordx4 v[172:175], v1, s[4:7], s31 offen sc1
  v_mfma_f32_16x16x32_bf16 v[48:51], v[136:139], v[124:127], v[48:51]
  v_mfma_f32_16x16x32_bf16 v[52:55], v[136:139], v[132:135], v[52:55]
  v_mfma_f32_16x16x32_bf16 v[56:59], v[140:143], v[124:127], v[56:59]
  v_mfma_f32_16x16x32_bf16 v[60:63], v[140:143], v[132:135], v[60:63]
  v_mfma_f32_16x16x32_bf16 v[64:67], v[144:147], v[124:127], v[64:67]
  v_mfma_f32_16x16x32_bf16 v[68:71], v[144:147], v[132:135], v[68:71]
  v_mfma_f32_16x16x32_bf16 v[72:75], v[148:151], v[124:127], v[72:75]
  v_mfma_f32_16x16x32_bf16 v[76:79], v[148:151], v[132:135], v[76:79]
  s_nop 0
  v_mul_f32 v160, v48, v48
  v_mul_f32 v161, v49, v49
  v_mul_f32 v162, v50, v50
  v_mul_f32 v163, v51, v51
  v_fma_f32 v160, v160, v178, v176
  v_fma_f32 v161, v161, v178, v176
  v_fma_f32 v162, v162, v178, v176
  v_fma_f32 v163, v163, v178, v176
  v_mul_f32 v160, v160, v48
  v_mul_f32 v161, v161, v49
  v_mul_f32 v162, v162, v50
  v_mul_f32 v163, v163, v51
  v_exp_f32 v160, v160
  v_mul_f32 v152, v48, v64
  v_exp_f32 v161, v161
  v_mul_f32 v153, v49, v65
  v_exp_f32 v162, v162
  v_mul_f32 v154, v50, v66
  v_exp_f32 v163, v163
  v_mul_f32 v155, v51, v67
  v_fma_f32 v160, v160, v122, v122
  v_fma_f32 v161, v161, v122, v122
  v_fma_f32 v162, v162, v122, v122
  v_fma_f32 v163, v163, v122, v122
  v_rcp_f32 v160, v160
  v_rcp_f32 v161, v161
  v_rcp_f32 v162, v162
  v_rcp_f32 v163, v163
  v_mul_f32 v152, v152, v160
  v_mul_f32 v153, v153, v161
  v_mul_f32 v154, v154, v162
  v_mul_f32 v155, v155, v163
  v_cvt_pk_bf16_f32 v168, v152, v153
  v_cvt_pk_bf16_f32 v169, v154, v155
  v_mul_f32 v164, v56, v56
  v_mul_f32 v165, v57, v57
  v_mul_f32 v166, v58, v58
  v_mul_f32 v167, v59, v59
  v_fma_f32 v164, v164, v178, v176
  v_fma_f32 v165, v165, v178, v176
  v_fma_f32 v166, v166, v178, v176
  v_fma_f32 v167, v167, v178, v176
  v_mul_f32 v164, v164, v56
  v_mul_f32 v165, v165, v57
  v_mul_f32 v166, v166, v58
  v_mul_f32 v167, v167, v59
  v_exp_f32 v164, v164
  v_mul_f32 v156, v56, v72
  v_exp_f32 v165, v165
  v_mul_f32 v157, v57, v73
  v_exp_f32 v166, v166
  v_mul_f32 v158, v58, v74
  v_exp_f32 v167, v167
  v_mul_f32 v159, v59, v75
  v_fma_f32 v164, v164, v122, v122
  v_fma_f32 v165, v165, v122, v122
  v_fma_f32 v166, v166, v122, v122
  v_fma_f32 v167, v167, v122, v122
  v_rcp_f32 v164, v164
  v_rcp_f32 v165, v165
  v_rcp_f32 v166, v166
  v_rcp_f32 v167, v167
  v_mul_f32 v156, v156, v164
  v_mul_f32 v157, v157, v165
  v_mul_f32 v158, v158, v166
  v_mul_f32 v159, v159, v167
  v_cvt_pk_bf16_f32 v170, v156, v157
  v_cvt_pk_bf16_f32 v171, v158, v159
  s_add_u32 s31, s49, 32768
  buffer_store_dwordx4 v[168:171], v1, s[4:7], s31 offen sc1
  v_mul_f32 v160, v52, v52
  v_mul_f32 v161, v53, v53
  v_mul_f32 v162, v54, v54
  v_mul_f32 v163, v55, v55
  v_fma_f32 v160, v160, v179, v177
  v_fma_f32 v161, v161, v179, v177
  v_fma_f32 v162, v162, v179, v177
  v_fma_f32 v163, v163, v179, v177
  v_mul_f32 v160, v160, v52
  v_mul_f32 v161, v161, v53
  v_mul_f32 v162, v162, v54
  v_mul_f32 v163, v163, v55
  v_exp_f32 v160, v160
  v_mul_f32 v152, v52, v68
  v_exp_f32 v161, v161
  v_mul_f32 v153, v53, v69
  v_exp_f32 v162, v162
  v_mul_f32 v154, v54, v70
  v_exp_f32 v163, v163
  v_mul_f32 v155, v55, v71
  v_fma_f32 v160, v160, v123, v123
  v_fma_f32 v161, v161, v123, v123
  v_fma_f32 v162, v162, v123, v123
  v_fma_f32 v163, v163, v123, v123
  v_rcp_f32 v160, v160
  v_rcp_f32 v161, v161
  v_rcp_f32 v162, v162
  v_rcp_f32 v163, v163
  v_mul_f32 v152, v152, v160
  v_mul_f32 v153, v153, v161
  v_mul_f32 v154, v154, v162
  v_mul_f32 v155, v155, v163
  v_cvt_pk_bf16_f32 v172, v152, v153
  v_cvt_pk_bf16_f32 v173, v154, v155
  v_mul_f32 v164, v60, v60
  v_mul_f32 v165, v61, v61
  v_mul_f32 v166, v62, v62
  v_mul_f32 v167, v63, v63
  v_fma_f32 v164, v164, v179, v177
  v_fma_f32 v165, v165, v179, v177
  v_fma_f32 v166, v166, v179, v177
  v_fma_f32 v167, v167, v179, v177
  v_mul_f32 v164, v164, v60
  v_mul_f32 v165, v165, v61
  v_mul_f32 v166, v166, v62
  v_mul_f32 v167, v167, v63
  v_exp_f32 v164, v164
  v_mul_f32 v156, v60, v76
  v_exp_f32 v165, v165
  v_mul_f32 v157, v61, v77
  v_exp_f32 v166, v166
  v_mul_f32 v158, v62, v78
  v_exp_f32 v167, v167
  v_mul_f32 v159, v63, v79
  v_fma_f32 v164, v164, v123, v123
  v_fma_f32 v165, v165, v123, v123
  v_fma_f32 v166, v166, v123, v123
  v_fma_f32 v167, v167, v123, v123
  v_rcp_f32 v164, v164
  v_rcp_f32 v165, v165
  v_rcp_f32 v166, v166
  v_rcp_f32 v167, v167
  v_mul_f32 v156, v156, v164
  v_mul_f32 v157, v157, v165
  v_mul_f32 v158, v158, v166
  v_mul_f32 v159, v159, v167
  v_cvt_pk_bf16_f32 v174, v156, v157
  v_cvt_pk_bf16_f32 v175, v158, v159
  s_add_u32 s31, s49, 81920
  buffer_store_dwordx4 v[172:175], v1, s[4:7], s31 offen sc1
  s_mul_i32 s27, s17, 384
  s_add_u32 s27, s27, s3
  s_add_u32 s27, s27, 0x2100
  s_waitcnt vmcnt(0) lgkmcnt(0)
  s_barrier
  s_cmp_lg_u32 s16, 0
  s_cbranch_scc1 M_sig_20
  s_mov_b64 exec, 1
  buffer_atomic_add v5, v4, s[4:7], s27 offen sc1
  s_mov_b64 exec, -1
M_sig_20:
  ds_read_b128 v[16:19], v218 offset:0
  ds_read_b128 v[20:23], v218 offset:1024
  ds_read_b128 v[24:27], v218 offset:2048
  ds_read_b128 v[28:31], v218 offset:3072
  ds_read_b128 v[32:35], v218 offset:4096
  s_waitcnt lgkmcnt(4)
  v_mfma_f32_16x16x32_bf16 v[48:51], v[16:19], a[160:163], 0
  ds_read_b128 v[36:39], v218 offset:10240
  s_add_u32 m0, s21, 81920
  v_mfma_f32_16x16x32_bf16 v[52:55], v[16:19], a[164:167], 0
  s_waitcnt lgkmcnt(4)
  s_add_u32 s48, s25, 102400
  v_mfma_f32_16x16x32_bf16 v[56:59], v[20:23], a[160:163], 0
  ds_read_b128 v[40:43], v218 offset:11264
  v_mfma_f32_16x16x32_bf16 v[60:63], v[20:23], a[164:167], 0
  s_waitcnt lgkmcnt(4)
  buffer_load_dwordx4 v1, s[4:7], s48 offen lds
  v_mfma_f32_16x16x32_bf16 v[64:67], v[24:27], a[160:163], 0
  ds_read_b128 v[44:47], v218 offset:12288
  v_mfma_f32_16x16x32_bf16 v[68:71], v[24:27], a[164:167], 0
  s_waitcnt lgkmcnt(4)
  buffer_load_dwordx4 v1, s[4:7], s48 offen offset:1024 lds
  v_mfma_f32_16x16x32_bf16 v[72:75], v[28:31], a[160:163], 0
  ds_read_b128 v[16:19], v218 offset:13312
  v_mfma_f32_16x16x32_bf16 v[76:79], v[28:31], a[164:167], 0
  s_waitcnt lgkmcnt(4)
  buffer_load_dwordx4 v1, s[4:7], s48 offen offset:2048 lds
  v_mfma_f32_16x16x32_bf16 v[80:83], v[32:35], a[160:163], 0
  ds_read_b128 v[20:23], v218 offset:14336
  v_mfma_f32_16x16x32_bf16 v[84:87], v[32:35], a[164:167], 0
  s_waitcnt lgkmcnt(4)
  buffer_load_dwordx4 v1, s[4:7], s48 offen offset:3072 lds
  v_mfma_f32_16x16x32_bf16 v[48:51], v[36:39], a[168:171], v[48:51]
  ds_read_b128 v[24:27], v218 offset:20480
  s_add_u32 m0, s21, 86016
  v_mfma_f32_16x16x32_bf16 v[52:55], v[36:39], a[172:175], v[52:55]
  s_waitcnt lgkmcnt(4)
  s_add_u32 s48, s25, 106496
  v_mfma_f32_16x16x32_bf16 v[56:59], v[40:43], a[168:171], v[56:59]
  ds_read_b128 v[28:31], v218 offset:21504
  v_mfma_f32_16x16x32_bf16 v[60:63], v[40:43], a[172:175], v[60:63]
  s_waitcnt lgkmcnt(4)
  buffer_load_dwordx4 v1, s[4:7], s48 offen lds
  v_mfma_f32_16x16x32_bf16 v[64:67], v[44:47], a[168:171], v[64:67]
  ds_read_b128 v[32:35], v218 offset:22528
  s_add_u32 m0, s21, 102400
  v_mfma_f32_16x16x32_bf16 v[68:71], v[44:47], a[172:175], v[68:71]
  s_waitcnt lgkmcnt(4)
  s_add_u32 s48, s25, 122880
  v_mfma_f32_16x16x32_bf16 v[72:75], v[16:19], a[168:171], v[72:75]
  ds_read_b128 v[36:39], v218 offset:23552
  v_mfma_f32_16x16x32_bf16 v[76:79], v[16:19], a[172:175], v[76:79]
  s_waitcnt lgkmcnt(4)
  buffer_load_dwordx4 v1, s[4:7], s48 offen lds
  v_mfma_f32_16x16x32_bf16 v[80:83], v[20:23], a[168:171], v[80:83]
  ds_read_b128 v[40:43], v218 offset:24576
  v_mfma_f32_16x16x32_bf16 v[84:87], v[20:23], a[172:175], v[84:87]
  s_waitcnt lgkmcnt(4)
  buffer_load_dwordx4 v1, s[4:7], s48 offen offset:1024 lds
  s_barrier
  v_mfma_f32_16x16x32_bf16 v[48:51], v[24:27], a[176:179], v[48:51]
  ds_read_b128 v[44:47], v218 offset:30720
  v_mfma_f32_16x16x32_bf16 v[52:55], v[24:27], a[180:183], v[52:55]
  s_waitcnt lgkmcnt(4)
  buffer_load_dwordx4 v1, s[4:7], s48 offen offset:2048 lds
  v_mfma_f32_16x16x32_bf16 v[56:59], v[28:31], a[176:179], v[56:59]
  ds_read_b128 v[16:19], v218 offset:31744
  v_mfma_f32_16x16x32_bf16 v[60:63], v[28:31], a[180:183], v[60:63]
  s_waitcnt lgkmcnt(4)
  buffer_load_dwordx4 v1, s[4:7], s48 offen offset:3072 lds
  v_mfma_f32_16x16x32_bf16 v[64:67], v[32:35], a[176:179], v[64:67]
  ds_read_b128 v[20:23], v218 offset:32768
  s_add_u32 m0, s21, 106496
  v_mfma_f32_16x16x32_bf16 v[68:71], v[32:35], a[180:183], v[68:71]
  s_waitcnt lgkmcnt(4)
  s_add_u32 s48, s25, 126976
  v_mfma_f32_16x16x32_bf16 v[72:75], v[36:39], a[176:179], v[72:75]
  ds_read_b128 v[24:27], v218 offset:33792
  v_mfma_f32_16x16x32_bf16 v[76:79], v[36:39], a[180:183], v[76:79]
  s_waitcnt lgkmcnt(4)
  buffer_load_dwordx4 v1, s[4:7], s48 offen lds
  v_mfma_f32_16x16x32_bf16 v[80:83], v[40:43], a[176:179], v[80:83]
  ds_read_b128 v[28:31], v218 offset:34816
  s_add_u32 m0, s21, 0
  v_mfma_f32_16x16x32_bf16 v[84:87], v[40:43], a[180:183], v[84:87]
  s_waitcnt lgkmcnt(4)
  s_add_u32 s48, s25, 143360
  v_mfma_f32_16x16x32_bf16 v[48:51], v[44:47], a[184:187], v[48:51]
  ds_read_b128 v[32:35], v8 offset:20480
  v_mfma_f32_16x16x32_bf16 v[52:55], v[44:47], a[188:191], v[52:55]
  s_waitcnt lgkmcnt(4)
  buffer_load_dwordx4 v1, s[4:7], s48 offen lds
  v_mfma_f32_16x16x32_bf16 v[56:59], v[16:19], a[184:187], v[56:59]
  ds_read_b128 v[36:39], v8 offset:21504
  v_mfma_f32_16x16x32_bf16 v[60:63], v[16:19], a[188:191], v[60:63]
  s_waitcnt lgkmcnt(4)
  buffer_load_dwordx4 v1, s[4:7], s48 offen offset:1024 lds
  v_mfma_f32_16x16x32_bf16 v[64:67], v[20:23], a[184:187], v[64:67]
  ds_read_b128 v[40:43], v8 offset:22528
  v_mfma_f32_16x16x32_bf16 v[68:71], v[20:23], a[188:191], v[68:71]
  s_waitcnt lgkmcnt(4)
  buffer_load_dwordx4 v1, s[4:7], s48 offen offset:2048 lds
  v_mfma_f32_16x16x32_bf16 v[72:75], v[24:27], a[184:187], v[72:75]
  ds_read_b128 v[44:47], v8 offset:23552
  v_mfma_f32_16x16x32_bf16 v[76:79], v[24:27], a[188:191], v[76:79]
  s_waitcnt lgkmcnt(4)
  buffer_load_dwordx4 v1, s[4:7], s48 offen offset:3072 lds
  v_mfma_f32_16x16x32_bf16 v[80:83], v[28:31], a[184:187], v[80:83]
  ds_read_b128 v[16:19], v8 offset:24576
  s_add_u32 m0, s21, 4096
  v_mfma_f32_16x16x32_bf16 v[84:87], v[28:31], a[188:191], v[84:87]
  s_waitcnt lgkmcnt(4)
  s_add_u32 s48, s25, 147456
  s_barrier
  v_mfma_f32_16x16x32_bf16 v[48:51], v[32:35], a[192:195], v[48:51]
  ds_read_b128 v[20:23], v8 offset:30720
  v_mfma_f32_16x16x32_bf16 v[52:55], v[32:35], a[196:199], v[52:55]
  s_waitcnt lgkmcnt(4)
  buffer_load_dwordx4 v1, s[4:7], s48 offen lds
  v_mfma_f32_16x16x32_bf16 v[56:59], v[36:39], a[192:195], v[56:59]
  ds_read_b128 v[24:27], v8 offset:31744
  s_add_u32 m0, s21, 122880
  v_mfma_f32_16x16x32_bf16 v[60:63], v[36:39], a[196:199], v[60:63]
  s_waitcnt lgkmcnt(4)
  s_add_u32 s48, s25, 163840
  v_mfma_f32_16x16x32_bf16 v[64:67], v[40:43], a[192:195], v[64:67]
  ds_read_b128 v[28:31], v8 offset:32768
  v_mfma_f32_16x16x32_bf16 v[68:71], v[40:43], a[196:199], v[68:71]
  s_waitcnt lgkmcnt(4)
  buffer_load_dwordx4 v1, s[4:7], s48 offen lds
  v_mfma_f32_16x16x32_bf16 v[72:75], v[44:47], a[192:195], v[72:75]
  ds_read_b128 v[32:35], v8 offset:33792
  v_mfma_f32_16x16x32_bf16 v[76:79], v[44:47], a[196:199], v[76:79]
  s_waitcnt lgkmcnt(4)
  buffer_load_dwordx4 v1, s[4:7], s48 offen offset:1024 lds
  v_mfma_f32_16x16x32_bf16 v[80:83], v[16:19], a[192:195], v[80:83]
  ds_read_b128 v[36:39], v8 offset:34816
  v_mfma_f32_16x16x32_bf16 v[84:87], v[16:19], a[196:199], v[84:87]
  s_waitcnt lgkmcnt(4)
  buffer_load_dwordx4 v1, s[4:7], s48 offen offset:2048 lds
  v_mfma_f32_16x16x32_bf16 v[48:51], v[20:23], a[200:203], v[48:51]
  ds_read_b128 v[40:43], v8 offset:40960
  v_mfma_f32_16x16x32_bf16 v[52:55], v[20:23], a[204:207], v[52:55]
  s_waitcnt lgkmcnt(4)
  buffer_load_dwordx4 v1, s[4:7], s48 offen offset:3072 lds
  v_mfma_f32_16x16x32_bf16 v[56:59], v[24:27], a[200:203], v[56:59]
  ds_read_b128 v[44:47], v8 offset:41984
  s_add_u32 m0, s21, 126976
  v_mfma_f32_16x16x32_bf16 v[60:63], v[24:27], a[204:207], v[60:63]
  s_waitcnt lgkmcnt(4)
  s_add_u32 s48, s25, 167936
  v_mfma_f32_16x16x32_bf16 v[64:67], v[28:31], a[200:203], v[64:67]
  ds_read_b128 v[16:19], v8 offset:43008
  v_mfma_f32_16x16x32_bf16 v[68:71], v[28:31], a[204:207], v[68:71]
  s_waitcnt lgkmcnt(4)
  buffer_load_dwordx4 v1, s[4:7], s48 offen lds
  v_mfma_f32_16x16x32_bf16 v[72:75], v[32:35], a[200:203], v[72:75]
  ds_read_b128 v[20:23], v8 offset:44032
  s_add_u32 m0, s21, 143360
  v_mfma_f32_16x16x32_bf16 v[76:79], v[32:35], a[204:207], v[76:79]
  s_waitcnt lgkmcnt(4)
  s_add_u32 s48, s25, 184320
  v_mfma_f32_16x16x32_bf16 v[80:83], v[36:39], a[200:203], v[80:83]
  ds_read_b128 v[24:27], v8 offset:45056
  buffer_load_dwordx4 v1, s[4:7], s48 offen lds
  buffer_load_dwordx4 v1, s[4:7], s48 offen offset:1024 lds
  buffer_load_dwordx4 v1, s[4:7], s48 offen offset:2048 lds
  buffer_load_dwordx4 v1, s[4:7], s48 offen offset:3072 lds
  s_add_u32 m0, s21, 147456
  s_add_u32 s48, s25, 188416
  buffer_load_dwordx4 v1, s[4:7], s48 offen lds
  buffer_load_dword v6, v4, s[4:7], s27 offen sc1
  v_mfma_f32_16x16x32_bf16 v[84:87], v[36:39], a[204:207], v[84:87]
  s_waitcnt lgkmcnt(4)
  s_waitcnt vmcnt(0)
  v_mov_b32 v6, v6
  v_cmp_gt_u32 vcc, 16, v6
  s_nop 4
  s_cbranch_vccz M_ck_21
  s_cmp_lg_u32 s40, 0
  s_cbranch_scc1 M_ck_21
  s_mov_b32 s41, 0
M_ckl_22:
  buffer_load_dword v6, v4, s[4:7], s27 offen sc1
  s_waitcnt vmcnt(0)
  v_cmp_gt_u32 vcc, 16, v6
  s_nop 4
  s_cbranch_vccz M_ck_21
  s_add_u32 s41, s41, 1
  s_cmp_lt_u32 s41, 40000
  s_cbranch_scc1 M_ckl_22
  s_mov_b32 s40, 1
M_ck_21:
  s_barrier
  v_mfma_f32_16x16x32_bf16 v[48:51], v[40:43], a[208:211], v[48:51]
  ds_read_b128 v[28:31], v8 offset:51200
  s_add_u32 s52, s50, 16384
  v_mfma_f32_16x16x32_bf16 v[52:55], v[40:43], a[212:215], v[52:55]
  s_waitcnt lgkmcnt(4)
  buffer_load_dwordx4 a[0:3], v1, s[4:7], s52 offen offset:0 sc1
  v_mfma_f32_16x16x32_bf16 v[56:59], v[44:47], a[208:211], v[56:59]
  ds_read_b128 v[32:35], v8 offset:52224
  s_add_u32 s53, s51, 16384
  v_mfma_f32_16x16x32_bf16 v[60:63], v[44:47], a[212:215], v[60:63]
  s_waitcnt lgkmcnt(4)
  buffer_load_dwordx4 a[4:7], v1, s[4:7], s53 offen offset:0 sc1
  v_mfma_f32_16x16x32_bf16 v[64:67], v[16:19], a[208:211], v[64:67]
  ds_read_b128 v[36:39], v8 offset:53248
  v_mfma_f32_16x16x32_bf16 v[68:71], v[16:19], a[212:215], v[68:71]
  s_waitcnt lgkmcnt(4)
  buffer_load_dwordx4 a[8:11], v1, s[4:7], s52 offen offset:2048 sc1
  v_mfma_f32_16x16x32_bf16 v[72:75], v[20:23], a[208:211], v[72:75]
  ds_read_b128 v[40:43], v8 offset:54272
  v_mfma_f32_16x16x32_bf16 v[76:79], v[20:23], a[212:215], v[76:79]
  s_waitcnt lgkmcnt(4)
  buffer_load_dwordx4 a[12:15], v1, s[4:7], s53 offen offset:2048 sc1
  v_mfma_f32_16x16x32_bf16 v[80:83], v[24:27], a[208:211], v[80:83]
  ds_read_b128 v[44:47], v8 offset:55296
  s_add_u32 s52, s50, 20480
  v_mfma_f32_16x16x32_bf16 v[84:87], v[24:27], a[212:215], v[84:87]
  s_waitcnt lgkmcnt(4)
  buffer_load_dwordx4 a[16:19], v1, s[4:7], s52 offen offset:0 sc1
  v_mfma_f32_16x16x32_bf16 v[48:51], v[28:31], a[216:219], v[48:51]
  ds_read_b128 v[16:19], v9 offset:0
  s_add_u32 s53, s51, 20480
  v_mfma_f32_16x16x32_bf16 v[52:55], v[28:31], a[220:223], v[52:55]
  s_waitcnt lgkmcnt(4)
  buffer_load_dwordx4 a[20:23], v1, s[4:7], s53 offen offset:0 sc1
  v_mfma_f32_16x16x32_bf16 v[56:59], v[32:35], a[216:219], v[56:59]
  ds_read_b128 v[20:23], v9 offset:1024
  v_mfma_f32_16x16x32_bf16 v[60:63], v[32:35], a[220:223], v[60:63]
  s_waitcnt lgkmcnt(4)
  buffer_load_dwordx4 a[24:27], v1, s[4:7], s52 offen offset:2048 sc1
  v_mfma_f32_16x16x32_bf16 v[64:67], v[36:39], a[216:219], v[64:67]
  ds_read_b128 v[24:27], v9 offset:2048
  v_mfma_f32_16x16x32_bf16 v[68:71], v[36:39], a[220:223], v[68:71]
  s_waitcnt lgkmcnt(4)
  buffer_load_dwordx4 a[28:31], v1, s[4:7], s53 offen offset:2048 sc1
  v_mfma_f32_16x16x32_bf16 v[72:75], v[40:43], a[216:219], v[72:75]
  ds_read_b128 v[28:31], v9 offset:3072
  s_add_u32 s52, s50, 24576
  v_mfma_f32_16x16x32_bf16 v[76:79], v[40:43], a[220:223], v[76:79]
  s_waitcnt lgkmcnt(4)
  buffer_load_dwordx4 a[32:35], v1, s[4:7], s52 offen offset:0 sc1
  v_mfma_f32_16x16x32_bf16 v[80:83], v[44:47], a[216:219], v[80:83]
  ds_read_b128 v[32:35], v9 offset:4096
  s_add_u32 s53, s51, 24576
  v_mfma_f32_16x16x32_bf16 v[84:87], v[44:47], a[220:223], v[84:87]
  s_waitcnt lgkmcnt(4)
  buffer_load_dwordx4 a[36:39], v1, s[4:7], s53 offen offset:0 sc1
  s_barrier
  s_waitcnt vmcnt(9)
  v_mfma_f32_16x16x32_bf16 v[48:51], v[16:19], a[0:3], v[48:51]
  ds_read_b128 v[36:39], v9 offset:10240
  s_waitcnt vmcnt(8)
  v_mfma_f32_16x16x32_bf16 v[52:55], v[16:19], a[4:7], v[52:55]
  s_waitcnt lgkmcnt(4)
  buffer_load_dwordx4 a[40:43], v1, s[4:7], s52 offen offset:2048 sc1
  v_mfma_f32_16x16x32_bf16 v[56:59], v[20:23], a[0:3], v[56:59]
  ds_read_b128 v[40:43], v9 offset:11264
  v_mfma_f32_16x16x32_bf16 v[60:63], v[20:23], a[4:7], v[60:63]
  s_waitcnt lgkmcnt(4)
  buffer_load_dwordx4 a[44:47], v1, s[4:7], s53 offen offset:2048 sc1
  v_mfma_f32_16x16x32_bf16 v[64:67], v[24:27], a[0:3], v[64:67]
  ds_read_b128 v[44:47], v9 offset:12288
  s_add_u32 s52, s50, 28672
  v_mfma_f32_16x16x32_bf16 v[68:71], v[24:27], a[4:7], v[68:71]
  s_waitcnt lgkmcnt(4)
  buffer_load_dwordx4 a[48:51], v1, s[4:7], s52 offen offset:0 sc1
  v_mfma_f32_16x16x32_bf16 v[72:75], v[28:31], a[0:3], v[72:75]
  ds_read_b128 v[16:19], v9 offset:13312
  s_add_u32 s53, s51, 28672
  v_mfma_f32_16x16x32_bf16 v[76:79], v[28:31], a[4:7], v[76:79]
  s_waitcnt lgkmcnt(4)
  buffer_load_dwordx4 a[52:55], v1, s[4:7], s53 offen offset:0 sc1
  v_mfma_f32_16x16x32_bf16 v[80:83], v[32:35], a[0:3], v[80:83]
  ds_read_b128 v[20:23], v9 offset:14336
  v_mfma_f32_16x16x32_bf16 v[84:87], v[32:35], a[4:7], v[84:87]
  s_waitcnt lgkmcnt(4)
  buffer_load_dwordx4 a[56:59], v1, s[4:7], s52 offen offset:2048 sc1
  s_waitcnt vmcnt(12)
  v_mfma_f32_16x16x32_bf16 v[48:51], v[36:39], a[8:11], v[48:51]
  ds_read_b128 v[24:27], v9 offset:20480
  s_waitcnt vmcnt(11)
  v_mfma_f32_16x16x32_bf16 v[52:55], v[36:39], a[12:15], v[52:55]
  s_waitcnt lgkmcnt(4)
  buffer_load_dwordx4 a[60:63], v1, s[4:7], s53 offen offset:2048 sc1
  v_mfma_f32_16x16x32_bf16 v[56:59], v[40:43], a[8:11], v[56:59]
  ds_read_b128 v[28:31], v9 offset:21504
  s_add_u32 s52, s50, 32768
  v_mfma_f32_16x16x32_bf16 v[60:63], v[40:43], a[12:15], v[60:63]
  s_waitcnt lgkmcnt(4)
  buffer_load_dwordx4 a[64:67], v1, s[4:7], s52 offen offset:0 sc1
  v_mfma_f32_16x16x32_bf16 v[64:67], v[44:47], a[8:11], v[64:67]
  ds_read_b128 v[32:35], v9 offset:22528
  s_add_u32 s53, s51, 32768
  v_mfma_f32_16x16x32_bf16 v[68:71], v[44:47], a[12:15], v[68:71]
  s_waitcnt lgkmcnt(4)
  buffer_load_dwordx4 a[68:71], v1, s[4:7], s53 offen offset:0 sc1
  v_mfma_f32_16x16x32_bf16 v[72:75], v[16:19], a[8:11], v[72:75]
  ds_read_b128 v[36:39], v9 offset:23552
  v_mfma_f32_16x16x32_bf16 v[76:79], v[16:19], a[12:15], v[76:79]
  s_waitcnt lgkmcnt(4)
  buffer_load_dwordx4 a[72:75], v1, s[4:7], s52 offen offset:2048 sc1
  v_mfma_f32_16x16x32_bf16 v[80:83], v[20:23], a[8:11], v[80:83]
  ds_read_b128 v[40:43], v9 offset:24576
  v_mfma_f32_16x16x32_bf16 v[84:87], v[20:23], a[12:15], v[84:87]
  s_waitcnt lgkmcnt(4)
  buffer_load_dwordx4 a[76:79], v1, s[4:7], s53 offen offset:2048 sc1
  s_barrier
  s_waitcnt vmcnt(15)
  v_mfma_f32_16x16x32_bf16 v[48:51], v[24:27], a[16:19], v[48:51]
  ds_read_b128 v[44:47], v9 offset:30720
  s_add_u32 m0, s21, 20480
  s_waitcnt vmcnt(14)
  v_mfma_f32_16x16x32_bf16 v[52:55], v[24:27], a[20:23], v[52:55]
  s_waitcnt lgkmcnt(4)
  s_add_u32 s48, s25, 204800
  v_mfma_f32_16x16x32_bf16 v[56:59], v[28:31], a[16:19], v[56:59]
  ds_read_b128 v[16:19], v9 offset:31744
  v_mfma_f32_16x16x32_bf16 v[60:63], v[28:31], a[20:23], v[60:63]
  s_waitcnt lgkmcnt(4)
  buffer_load_dwordx4 v1, s[4:7], s48 offen lds
  v_mfma_f32_16x16x32_bf16 v[64:67], v[32:35], a[16:19], v[64:67]
  ds_read_b128 v[20:23], v9 offset:32768
  v_mfma_f32_16x16x32_bf16 v[68:71], v[32:35], a[20:23], v[68:71]
  s_waitcnt lgkmcnt(4)
  buffer_load_dwordx4 v1, s[4:7], s48 offen offset:1024 lds
  v_mfma_f32_16x16x32_bf16 v[72:75], v[36:39], a[16:19], v[72:75]
  ds_read_b128 v[24:27], v9 offset:33792
  v_mfma_f32_16x16x32_bf16 v[76:79], v[36:39], a[20:23], v[76:79]
  s_waitcnt lgkmcnt(4)
  buffer_load_dwordx4 v1, s[4:7], s48 offen offset:2048 lds
  v_mfma_f32_16x16x32_bf16 v[80:83], v[40:43], a[16:19], v[80:83]
  ds_read_b128 v[28:31], v9 offset:34816
  v_mfma_f32_16x16x32_bf16 v[84:87], v[40:43], a[20:23], v[84:87]
  s_waitcnt lgkmcnt(4)
  buffer_load_dwordx4 v1, s[4:7], s48 offen offset:3072 lds
  s_waitcnt vmcnt(17)
  v_mfma_f32_16x16x32_bf16 v[48:51], v[44:47], a[24:27], v[48:51]
  ds_read_b128 v[32:35], v9 offset:40960
  s_add_u32 m0, s21, 24576
  s_waitcnt vmcnt(16)
  v_mfma_f32_16x16x32_bf16 v[52:55], v[44:47], a[28:31], v[52:55]
  s_waitcnt lgkmcnt(4)
  s_add_u32 s48, s25, 208896
  v_mfma_f32_16x16x32_bf16 v[56:59], v[16:19], a[24:27], v[56:59]
  ds_read_b128 v[36:39], v9 offset:41984
  v_mfma_f32_16x16x32_bf16 v[60:63], v[16:19], a[28:31], v[60:63]
  s_waitcnt lgkmcnt(4)
  buffer_load_dwordx4 v1, s[4:7], s48 offen lds
  v_mfma_f32_16x16x32_bf16 v[64:67], v[20:23], a[24:27], v[64:67]
  ds_read_b128 v[40:43], v9 offset:43008
  s_add_u32 s52, s50, 36864
  v_mfma_f32_16x16x32_bf16 v[68:71], v[20:23], a[28:31], v[68:71]
  s_waitcnt lgkmcnt(4)
  buffer_load_dwordx4 a[80:83], v1, s[4:7], s52 offen offset:0 sc1
  v_mfma_f32_16x16x32_bf16 v[72:75], v[24:27], a[24:27], v[72:75]
  ds_read_b128 v[44:47], v9 offset:44032
  s_add_u32 s53, s51, 36864
  v_mfma_f32_16x16x32_bf16 v[76:79], v[24:27], a[28:31], v[76:79]
  s_waitcnt lgkmcnt(4)
  buffer_load_dwordx4 a[84:87], v1, s[4:7], s53 offen offset:0 sc1
  v_mfma_f32_16x16x32_bf16 v[80:83], v[28:31], a[24:27], v[80:83]
  ds_read_b128 v[16:19], v9 offset:45056
  v_mfma_f32_16x16x32_bf16 v[84:87], v[28:31], a[28:31], v[84:87]
  s_waitcnt lgkmcnt(4)
  buffer_load_dwordx4 a[88:91], v1, s[4:7], s52 offen offset:2048 sc1
  s_barrier
  s_waitcnt vmcnt(19)
  v_mfma_f32_16x16x32_bf16 v[48:51], v[32:35], a[32:35], v[48:51]
  ds_read_b128 v[20:23], v9 offset:51200
  s_waitcnt vmcnt(18)
  v_mfma_f32_16x16x32_bf16 v[52:55], v[32:35], a[36:39], v[52:55]
  s_waitcnt lgkmcnt(4)
  buffer_load_dwordx4 a[92:95], v1, s[4:7], s53 offen offset:2048 sc1
  v_mfma_f32_16x16x32_bf16 v[56:59], v[36:39], a[32:35], v[56:59]
  ds_read_b128 v[24:27], v9 offset:52224
  s_add_u32 m0, s21, 40960
  v_mfma_f32_16x16x32_bf16 v[60:63], v[36:39], a[36:39], v[60:63]
  s_waitcnt lgkmcnt(4)
  s_add_u32 s48, s25, 225280
  v_mfma_f32_16x16x32_bf16 v[64:67], v[40:43], a[32:35], v[64:67]
  ds_read_b128 v[28:31], v9 offset:53248
  v_mfma_f32_16x16x32_bf16 v[68:71], v[40:43], a[36:39], v[68:71]
  s_waitcnt lgkmcnt(4)
  buffer_load_dwordx4 v1, s[4:7], s48 offen lds
  v_mfma_f32_16x16x32_bf16 v[72:75], v[44:47], a[32:35], v[72:75]
  ds_read_b128 v[32:35], v9 offset:54272
  v_mfma_f32_16x16x32_bf16 v[76:79], v[44:47], a[36:39], v[76:79]
  s_waitcnt lgkmcnt(4)
  buffer_load_dwordx4 v1, s[4:7], s48 offen offset:1024 lds
  v_mfma_f32_16x16x32_bf16 v[80:83], v[16:19], a[32:35], v[80:83]
  ds_read_b128 v[36:39], v9 offset:55296
  v_mfma_f32_16x16x32_bf16 v[84:87], v[16:19], a[36:39], v[84:87]
  s_waitcnt lgkmcnt(4)
  buffer_load_dwordx4 v1, s[4:7], s48 offen offset:2048 lds
  s_waitcnt vmcnt(21)
  v_mfma_f32_16x16x32_bf16 v[48:51], v[20:23], a[40:43], v[48:51]
  ds_read_b128 v[40:43], v8 offset:0
  s_waitcnt vmcnt(20)
  v_mfma_f32_16x16x32_bf16 v[52:55], v[20:23], a[44:47], v[52:55]
  s_waitcnt lgkmcnt(4)
  buffer_load_dwordx4 v1, s[4:7], s48 offen offset:3072 lds
  v_mfma_f32_16x16x32_bf16 v[56:59], v[24:27], a[40:43], v[56:59]
  ds_read_b128 v[44:47], v8 offset:1024
  s_add_u32 m0, s21, 45056
  v_mfma_f32_16x16x32_bf16 v[60:63], v[24:27], a[44:47], v[60:63]
  s_waitcnt lgkmcnt(4)
  s_add_u32 s48, s25, 229376
  v_mfma_f32_16x16x32_bf16 v[64:67], v[28:31], a[40:43], v[64:67]
  ds_read_b128 v[16:19], v8 offset:2048
  v_mfma_f32_16x16x32_bf16 v[68:71], v[28:31], a[44:47], v[68:71]
  s_waitcnt lgkmcnt(4)
  buffer_load_dwordx4 v1, s[4:7], s48 offen lds
  v_mfma_f32_16x16x32_bf16 v[72:75], v[32:35], a[40:43], v[72:75]
  ds_read_b128 v[20:23], v8 offset:3072
  s_add_u32 s52, s50, 40960
  v_mfma_f32_16x16x32_bf16 v[76:79], v[32:35], a[44:47], v[76:79]
  s_waitcnt lgkmcnt(4)
  buffer_load_dwordx4 a[96:99], v1, s[4:7], s52 offen offset:0 sc1
  v_mfma_f32_16x16x32_bf16 v[80:83], v[36:39], a[40:43], v[80:83]
  ds_read_b128 v[24:27], v8 offset:4096
  s_add_u32 s53, s51, 40960
  v_mfma_f32_16x16x32_bf16 v[84:87], v[36:39], a[44:47], v[84:87]
  s_waitcnt lgkmcnt(4)
  buffer_load_dwordx4 a[100:103], v1, s[4:7], s53 offen offset:0 sc1
  s_barrier
  s_waitcnt vmcnt(23)
  v_mfma_f32_16x16x32_bf16 v[48:51], v[40:43], a[48:51], v[48:51]
  ds_read_b128 v[28:31], v8 offset:10240
  s_waitcnt vmcnt(22)
  v_mfma_f32_16x16x32_bf16 v[52:55], v[40:43], a[52:55], v[52:55]
  s_waitcnt lgkmcnt(4)
  buffer_load_dwordx4 a[104:107], v1, s[4:7], s52 offen offset:2048 sc1
  v_mfma_f32_16x16x32_bf16 v[56:59], v[44:47], a[48:51], v[56:59]
  ds_read_b128 v[32:35], v8 offset:11264
  v_mfma_f32_16x16x32_bf16 v[60:63], v[44:47], a[52:55], v[60:63]
  s_waitcnt lgkmcnt(4)
  buffer_load_dwordx4 a[108:111], v1, s[4:7], s53 offen offset:2048 sc1
  v_mfma_f32_16x16x32_bf16 v[64:67], v[16:19], a[48:51], v[64:67]
  ds_read_b128 v[36:39], v8 offset:12288
  s_add_u32 s52, s50, 45056
  v_mfma_f32_16x16x32_bf16 v[68:71], v[16:19], a[52:55], v[68:71]
  s_waitcnt lgkmcnt(4)
  buffer_load_dwordx4 a[112:115], v1, s[4:7], s52 offen offset:0 sc1
  v_mfma_f32_16x16x32_bf16 v[72:75], v[20:23], a[48:51], v[72:75]
  ds_read_b128 v[40:43], v8 offset:13312
  s_add_u32 s53, s51, 45056
  v_mfma_f32_16x16x32_bf16 v[76:79], v[20:23], a[52:55], v[76:79]
  s_waitcnt lgkmcnt(4)
  buffer_load_dwordx4 a[116:119], v1, s[4:7], s53 offen offset:0 sc1
  v_mfma_f32_16x16x32_bf16 v[80:83], v[24:27], a[48:51], v[80:83]
  ds_read_b128 v[44:47], v8 offset:14336
  v_mfma_f32_16x16x32_bf16 v[84:87], v[24:27], a[52:55], v[84:87]
  s_waitcnt lgkmcnt(4)
  buffer_load_dwordx4 a[120:123], v1, s[4:7], s52 offen offset:2048 sc1
  s_waitcnt vmcnt(26)
  v_mfma_f32_16x16x32_bf16 v[48:51], v[28:31], a[56:59], v[48:51]
  ds_read_b128 v[16:19], v218 offset:0
  s_waitcnt vmcnt(25)
  v_mfma_f32_16x16x32_bf16 v[52:55], v[28:31], a[60:63], v[52:55]
  s_waitcnt lgkmcnt(4)
  buffer_load_dwordx4 a[124:127], v1, s[4:7], s53 offen offset:2048 sc1
  v_mfma_f32_16x16x32_bf16 v[56:59], v[32:35], a[56:59], v[56:59]
  ds_read_b128 v[20:23], v218 offset:1024
  v_mfma_f32_16x16x32_bf16 v[60:63], v[32:35], a[60:63], v[60:63]
  s_waitcnt lgkmcnt(4)
  v_mfma_f32_16x16x32_bf16 v[64:67], v[36:39], a[56:59], v[64:67]
  ds_read_b128 v[24:27], v218 offset:2048
  v_mfma_f32_16x16x32_bf16 v[68:71], v[36:39], a[60:63], v[68:71]
  s_waitcnt lgkmcnt(4)
  v_mfma_f32_16x16x32_bf16 v[72:75], v[40:43], a[56:59], v[72:75]
  ds_read_b128 v[28:31], v218 offset:3072
  v_mfma_f32_16x16x32_bf16 v[76:79], v[40:43], a[60:63], v[76:79]
  s_waitcnt lgkmcnt(4)
  v_mfma_f32_16x16x32_bf16 v[80:83], v[44:47], a[56:59], v[80:83]
  ds_read_b128 v[32:35], v218 offset:4096
  v_mfma_f32_16x16x32_bf16 v[84:87], v[44:47], a[60:63], v[84:87]
  s_waitcnt lgkmcnt(4)
  s_barrier
  s_waitcnt vmcnt(25)
  v_mfma_f32_16x16x32_bf16 v[48:51], v[16:19], a[64:67], v[48:51]
  ds_read_b128 v[36:39], v218 offset:10240
  s_waitcnt vmcnt(24)
  v_mfma_f32_16x16x32_bf16 v[52:55], v[16:19], a[68:71], v[52:55]
  s_waitcnt lgkmcnt(4)
  v_mfma_f32_16x16x32_bf16 v[56:59], v[20:23], a[64:67], v[56:59]
  ds_read_b128 v[40:43], v218 offset:11264
  v_mfma_f32_16x16x32_bf16 v[60:63], v[20:23], a[68:71], v[60:63]
  s_waitcnt lgkmcnt(4)
  v_mfma_f32_16x16x32_bf16 v[64:67], v[24:27], a[64:67], v[64:67]
  ds_read_b128 v[44:47], v218 offset:12288
  v_mfma_f32_16x16x32_bf16 v[68:71], v[24:27], a[68:71], v[68:71]
  s_waitcnt lgkmcnt(4)
  v_mfma_f32_16x16x32_bf16 v[72:75], v[28:31], a[64:67], v[72:75]
  ds_read_b128 v[16:19], v218 offset:13312
  v_mfma_f32_16x16x32_bf16 v[76:79], v[28:31], a[68:71], v[76:79]
  s_waitcnt lgkmcnt(4)
  v_mfma_f32_16x16x32_bf16 v[80:83], v[32:35], a[64:67], v[80:83]
  ds_read_b128 v[20:23], v218 offset:14336
  v_mfma_f32_16x16x32_bf16 v[84:87], v[32:35], a[68:71], v[84:87]
  s_waitcnt lgkmcnt(4)
  s_waitcnt vmcnt(23)
  v_mfma_f32_16x16x32_bf16 v[48:51], v[36:39], a[72:75], v[48:51]
  ds_read_b128 v[24:27], v218 offset:20480
  s_waitcnt vmcnt(22)
  v_mfma_f32_16x16x32_bf16 v[52:55], v[36:39], a[76:79], v[52:55]
  s_waitcnt lgkmcnt(4)
  v_mfma_f32_16x16x32_bf16 v[56:59], v[40:43], a[72:75], v[56:59]
  ds_read_b128 v[28:31], v218 offset:21504
  v_mfma_f32_16x16x32_bf16 v[60:63], v[40:43], a[76:79], v[60:63]
  s_waitcnt lgkmcnt(4)
  v_mfma_f32_16x16x32_bf16 v[64:67], v[44:47], a[72:75], v[64:67]
  ds_read_b128 v[32:35], v218 offset:22528
  v_mfma_f32_16x16x32_bf16 v[68:71], v[44:47], a[76:79], v[68:71]
  s_waitcnt lgkmcnt(4)
  v_mfma_f32_16x16x32_bf16 v[72:75], v[16:19], a[72:75], v[72:75]
  ds_read_b128 v[36:39], v218 offset:23552
  v_mfma_f32_16x16x32_bf16 v[76:79], v[16:19], a[76:79], v[76:79]
  s_waitcnt lgkmcnt(4)
  v_mfma_f32_16x16x32_bf16 v[80:83], v[20:23], a[72:75], v[80:83]
  ds_read_b128 v[40:43], v218 offset:24576
  v_mfma_f32_16x16x32_bf16 v[84:87], v[20:23], a[76:79], v[84:87]
  s_waitcnt lgkmcnt(4)
  s_waitcnt vmcnt(17)
  s_barrier
  s_waitcnt vmcnt(16)
  v_mfma_f32_16x16x32_bf16 v[48:51], v[24:27], a[80:83], v[48:51]
  ds_read_b128 v[44:47], v218 offset:30720
  s_waitcnt vmcnt(15)
  v_mfma_f32_16x16x32_bf16 v[52:55], v[24:27], a[84:87], v[52:55]
  s_waitcnt lgkmcnt(4)
  v_mfma_f32_16x16x32_bf16 v[56:59], v[28:31], a[80:83], v[56:59]
  ds_read_b128 v[16:19], v218 offset:31744
  v_mfma_f32_16x16x32_bf16 v[60:63], v[28:31], a[84:87], v[60:63]
  s_waitcnt lgkmcnt(4)
  v_mfma_f32_16x16x32_bf16 v[64:67], v[32:35], a[80:83], v[64:67]
  ds_read_b128 v[20:23], v218 offset:32768
  v_mfma_f32_16x16x32_bf16 v[68:71], v[32:35], a[84:87], v[68:71]
  s_waitcnt lgkmcnt(4)
  v_mfma_f32_16x16x32_bf16 v[72:75], v[36:39], a[80:83], v[72:75]
  ds_read_b128 v[24:27], v218 offset:33792
  v_mfma_f32_16x16x32_bf16 v[76:79], v[36:39], a[84:87], v[76:79]
  s_waitcnt lgkmcnt(4)
  v_mfma_f32_16x16x32_bf16 v[80:83], v[40:43], a[80:83], v[80:83]
  ds_read_b128 v[28:31], v218 offset:34816
  v_mfma_f32_16x16x32_bf16 v[84:87], v[40:43], a[84:87], v[84:87]
  s_waitcnt lgkmcnt(4)
  s_waitcnt vmcnt(14)
  v_mfma_f32_16x16x32_bf16 v[48:51], v[44:47], a[88:91], v[48:51]
  ds_read_b128 v[32:35], v8 offset:20480
  s_waitcnt vmcnt(13)
  v_mfma_f32_16x16x32_bf16 v[52:55], v[44:47], a[92:95], v[52:55]
  s_waitcnt lgkmcnt(4)
  v_mfma_f32_16x16x32_bf16 v[56:59], v[16:19], a[88:91], v[56:59]
  ds_read_b128 v[36:39], v8 offset:21504
  v_mfma_f32_16x16x32_bf16 v[60:63], v[16:19], a[92:95], v[60:63]
  s_waitcnt lgkmcnt(4)
  v_mfma_f32_16x16x32_bf16 v[64:67], v[20:23], a[88:91], v[64:67]
  ds_read_b128 v[40:43], v8 offset:22528
  v_mfma_f32_16x16x32_bf16 v[68:71], v[20:23], a[92:95], v[68:71]
  s_waitcnt lgkmcnt(4)
  v_mfma_f32_16x16x32_bf16 v[72:75], v[24:27], a[88:91], v[72:75]
  ds_read_b128 v[44:47], v8 offset:23552
  v_mfma_f32_16x16x32_bf16 v[76:79], v[24:27], a[92:95], v[76:79]
  s_waitcnt lgkmcnt(4)
  v_mfma_f32_16x16x32_bf16 v[80:83], v[28:31], a[88:91], v[80:83]
  ds_read_b128 v[16:19], v8 offset:24576
  v_mfma_f32_16x16x32_bf16 v[84:87], v[28:31], a[92:95], v[84:87]
  s_waitcnt lgkmcnt(4)
  s_waitcnt vmcnt(8)
  s_barrier
  s_waitcnt vmcnt(7)
  v_mfma_f32_16x16x32_bf16 v[48:51], v[32:35], a[96:99], v[48:51]
  ds_read_b128 v[20:23], v8 offset:30720
  v_lshlrev_b32 v112, 16, v240
  s_waitcnt vmcnt(6)
  v_mfma_f32_16x16x32_bf16 v[52:55], v[32:35], a[100:103], v[52:55]
  s_waitcnt lgkmcnt(4)
  v_and_b32 v113, 0xffff0000, v240
  v_lshlrev_b32 v114, 16, v241
  v_mfma_f32_16x16x32_bf16 v[56:59], v[36:39], a[96:99], v[56:59]
  ds_read_b128 v[24:27], v8 offset:31744
  v_and_b32 v115, 0xffff0000, v241
  v_mfma_f32_16x16x32_bf16 v[60:63], v[36:39], a[100:103], v[60:63]
  s_waitcnt lgkmcnt(4)
  v_lshlrev_b32 v116, 16, v242
  v_and_b32 v117, 0xffff0000, v242
  v_mfma_f32_16x16x32_bf16 v[64:67], v[40:43], a[96:99], v[64:67]
  ds_read_b128 v[28:31], v8 offset:32768
  v_lshlrev_b32 v118, 16, v243
  v_mfma_f32_16x16x32_bf16 v[68:71], v[40:43], a[100:103], v[68:71]
  s_waitcnt lgkmcnt(4)
  v_and_b32 v119, 0xffff0000, v243
  v_lshlrev_b32 v120, 16, v244
  v_mfma_f32_16x16x32_bf16 v[72:75], v[44:47], a[96:99], v[72:75]
  ds_read_b128 v[32:35], v8 offset:33792
  v_and_b32 v121, 0xffff0000, v244
  v_mfma_f32_16x16x32_bf16 v[76:79], v[44:47], a[100:103], v[76:79]
  s_waitcnt lgkmcnt(4)
  v_lshlrev_b32 v122, 16, v245
  v_and_b32 v123, 0xffff0000, v245
  v_mfma_f32_16x16x32_bf16 v[80:83], v[16:19], a[96:99], v[80:83]
  ds_read_b128 v[36:39], v8 offset:34816
  v_lshlrev_b32 v124, 16, v246
  v_mfma_f32_16x16x32_bf16 v[84:87], v[16:19], a[100:103], v[84:87]
  s_waitcnt lgkmcnt(4)
  v_and_b32 v125, 0xffff0000, v246
  v_lshlrev_b32 v126, 16, v247
  s_waitcnt vmcnt(5)
  v_mfma_f32_16x16x32_bf16 v[48:51], v[20:23], a[104:107], v[48:51]
  ds_read_b128 v[40:43], v8 offset:40960
  v_and_b32 v127, 0xffff0000, v247
  s_waitcnt vmcnt(4)
  v_mfma_f32_16x16x32_bf16 v[52:55], v[20:23], a[108:111], v[52:55]
  s_waitcnt lgkmcnt(4)
  v_lshlrev_b32 v128, 16, v248
  v_and_b32 v129, 0xffff0000, v248
  v_mfma_f32_16x16x32_bf16 v[56:59], v[24:27], a[104:107], v[56:59]
  ds_read_b128 v[44:47], v8 offset:41984
  v_lshlrev_b32 v130, 16, v249
  v_mfma_f32_16x16x32_bf16 v[60:63], v[24:27], a[108:111], v[60:63]
  s_waitcnt lgkmcnt(4)
  v_and_b32 v131, 0xffff0000, v249
  v_mfma_f32_16x16x32_bf16 v[64:67], v[28:31], a[104:107], v[64:67]
  ds_read_b128 v[16:19], v8 offset:43008
  v_mfma_f32_16x16x32_bf16 v[68:71], v[28:31], a[108:111], v[68:71]
  s_waitcnt lgkmcnt(4)
  v_mfma_f32_16x16x32_bf16 v[72:75], v[32:35], a[104:107], v[72:75]
  ds_read_b128 v[20:23], v8 offset:44032
  v_mfma_f32_16x16x32_bf16 v[76:79], v[32:35], a[108:111], v[76:79]
  s_waitcnt lgkmcnt(4)
  v_mfma_f32_16x16x32_bf16 v[80:83], v[36:39], a[104:107], v[80:83]
  ds_read_b128 v[24:27], v8 offset:45056
  v_mfma_f32_16x16x32_bf16 v[84:87], v[36:39], a[108:111], v[84:87]
  s_waitcnt lgkmcnt(4)
  s_barrier
  s_waitcnt vmcnt(3)
  v_mfma_f32_16x16x32_bf16 v[48:51], v[40:43], a[112:115], v[48:51]
  ds_read_b128 v[28:31], v8 offset:51200
  s_waitcnt vmcnt(2)
  v_mfma_f32_16x16x32_bf16 v[52:55], v[40:43], a[116:119], v[52:55]
  s_waitcnt lgkmcnt(4)
  v_mfma_f32_16x16x32_bf16 v[56:59], v[44:47], a[112:115], v[56:59]
  ds_read_b128 v[32:35], v8 offset:52224
  v_mfma_f32_16x16x32_bf16 v[60:63], v[44:47], a[116:119], v[60:63]
  s_waitcnt lgkmcnt(4)
  v_mfma_f32_16x16x32_bf16 v[64:67], v[16:19], a[112:115], v[64:67]
  ds_read_b128 v[36:39], v8 offset:53248
  v_mfma_f32_16x16x32_bf16 v[68:71], v[16:19], a[116:119], v[68:71]
  s_waitcnt lgkmcnt(4)
  v_mfma_f32_16x16x32_bf16 v[72:75], v[20:23], a[112:115], v[72:75]
  ds_read_b128 v[40:43], v8 offset:54272
  v_mfma_f32_16x16x32_bf16 v[76:79], v[20:23], a[116:119], v[76:79]
  s_waitcnt lgkmcnt(4)
  v_mfma_f32_16x16x32_bf16 v[80:83], v[24:27], a[112:115], v[80:83]
  ds_read_b128 v[44:47], v8 offset:55296
  v_mfma_f32_16x16x32_bf16 v[84:87], v[24:27], a[116:119], v[84:87]
  s_waitcnt lgkmcnt(4)
  s_waitcnt vmcnt(1)
  v_mfma_f32_16x16x32_bf16 v[48:51], v[28:31], a[120:123], v[48:51]
  s_waitcnt vmcnt(0)
  v_mfma_f32_16x16x32_bf16 v[52:55], v[28:31], a[124:127], v[52:55]
  s_waitcnt lgkmcnt(3)
  v_mfma_f32_16x16x32_bf16 v[56:59], v[32:35], a[120:123], v[56:59]
  v_mfma_f32_16x16x32_bf16 v[60:63], v[32:35], a[124:127], v[60:63]
  s_waitcnt lgkmcnt(2)
  v_mfma_f32_16x16x32_bf16 v[64:67], v[36:39], a[120:123], v[64:67]
  v_mfma_f32_16x16x32_bf16 v[68:71], v[36:39], a[124:127], v[68:71]
  s_waitcnt lgkmcnt(1)
  v_mfma_f32_16x16x32_bf16 v[72:75], v[40:43], a[120:123], v[72:75]
  v_mfma_f32_16x16x32_bf16 v[76:79], v[40:43], a[124:127], v[76:79]
  s_waitcnt lgkmcnt(0)
  v_mfma_f32_16x16x32_bf16 v[80:83], v[44:47], a[120:123], v[80:83]
  v_mfma_f32_16x16x32_bf16 v[84:87], v[44:47], a[124:127], v[84:87]
  ds_write_b128 v255, v[52:55] offset:0
  ds_write_b128 v255, v[60:63] offset:1024
  ds_write_b128 v255, v[68:71] offset:2048
  s_nop 1
  ds_write_b128 v255, v[76:79] offset:3072
  s_nop 1
  ds_write_b128 v255, v[84:87] offset:4096
  s_waitcnt lgkmcnt(0)
  s_barrier
  ds_read_b128 v[88:91], v15 offset:0
  ds_read_b128 v[92:95], v15 offset:1024
  ds_read_b128 v[96:99], v15 offset:2048
  ds_read_b128 v[100:103], v15 offset:3072
  ds_read_b128 v[104:107], v15 offset:4096
  v_add_f32 v112, v112, v48
  v_add_f32 v113, v113, v49
  v_add_f32 v114, v114, v50
  v_add_f32 v115, v115, v51
  v_add_f32 v116, v116, v56
  v_add_f32 v117, v117, v57
  v_add_f32 v118, v118, v58
  v_add_f32 v119, v119, v59
  v_add_f32 v120, v120, v64
  v_add_f32 v121, v121, v65
  v_add_f32 v122, v122, v66
  v_add_f32 v123, v123, v67
  v_add_f32 v124, v124, v72
  v_add_f32 v125, v125, v73
  v_add_f32 v126, v126, v74
  v_add_f32 v127, v127, v75
  v_add_f32 v128, v128, v80
  v_add_f32 v129, v129, v81
  v_add_f32 v130, v130, v82
  v_add_f32 v131, v131, v83
  s_waitcnt lgkmcnt(4)
  v_add_f32 v112, v112, v88
  v_add_f32 v113, v113, v89
  v_add_f32 v114, v114, v90
  v_add_f32 v115, v115, v91
  s_waitcnt lgkmcnt(3)
  v_add_f32 v116, v116, v92
  v_add_f32 v117, v117, v93
  v_add_f32 v118, v118, v94
  v_add_f32 v119, v119, v95
  s_waitcnt lgkmcnt(2)
  v_add_f32 v120, v120, v96
  v_add_f32 v121, v121, v97
  v_add_f32 v122, v122, v98
  v_add_f32 v123, v123, v99
  s_waitcnt lgkmcnt(1)
  v_add_f32 v124, v124, v100
  v_add_f32 v125, v125, v101
  v_add_f32 v126, v126, v102
  v_add_f32 v127, v127, v103
  s_waitcnt lgkmcnt(0)
  v_add_f32 v128, v128, v104
  v_add_f32 v129, v129, v105
  v_add_f32 v130, v130, v106
  v_add_f32 v131, v131, v107
  v_cvt_pk_bf16_f32 v240, v112, v113
  v_cvt_pk_bf16_f32 v241, v114, v115
  v_cvt_pk_bf16_f32 v242, v116, v117
  v_cvt_pk_bf16_f32 v243, v118, v119
  v_cvt_pk_bf16_f32 v244, v120, v121
  v_cvt_pk_bf16_f32 v245, v122, v123
  v_cvt_pk_bf16_f32 v246, v124, v125
  v_cvt_pk_bf16_f32 v247, v126, v127
  v_cvt_pk_bf16_f32 v248, v128, v129
  v_cvt_pk_bf16_f32 v249, v130, v131
  s_cmp_lg_u32 s19, 0
  s_cbranch_scc1 M_d_last_23
  s_lshr_b32 s26, s45, 1
  s_mul_i32 s26, s26, 40960
  s_add_u32 s26, s26, s20
  s_add_u32 s26, s26, 0xf00000
  buffer_store_dwordx4 v[240:243], v238, s[4:7], s26 offen sc1
  buffer_store_dwordx4 v[244:247], v239, s[4:7], s26 offen sc1
  buffer_store_dwordx2 v[248:249], v250, s[4:7], s26 offen sc1
  v_mov_b32 v136, 0
  v_mov_b32 v137, 0
  v_dot2c_f32_bf16 v136, v240, v3
  v_dot2c_f32_bf16 v137, v240, v240
  v_dot2c_f32_bf16 v136, v241, v3
  v_dot2c_f32_bf16 v137, v241, v241
  v_dot2c_f32_bf16 v136, v242, v3
  v_dot2c_f32_bf16 v137, v242, v242
  v_dot2c_f32_bf16 v136, v243, v3
  v_dot2c_f32_bf16 v137, v243, v243
  v_dot2c_f32_bf16 v136, v244, v3
  v_dot2c_f32_bf16 v137, v244, v244
  v_dot2c_f32_bf16 v136, v245, v3
  v_dot2c_f32_bf16 v137, v245, v245
  v_dot2c_f32_bf16 v136, v246, v3
  v_dot2c_f32_bf16 v137, v246, v246
  v_dot2c_f32_bf16 v136, v247, v3
  v_dot2c_f32_bf16 v137, v247, v247
  v_dot2c_f32_bf16 v136, v248, v3
  v_dot2c_f32_bf16 v137, v248, v248
  v_dot2c_f32_bf16 v136, v249, v3
  v_dot2c_f32_bf16 v137, v249, v249
  s_nop 1
  v_mov_b32 v138, v136
  v_mov_b32 v139, v137
  s_nop 0
  v_permlane16_swap_b32 v136, v138
  v_permlane16_swap_b32 v137, v139
  v_add_f32 v136, v136, v138
  v_add_f32 v137, v137, v139
  v_mov_b32 v138, v136
  v_mov_b32 v139, v137
  s_nop 0
  v_permlane32_swap_b32 v136, v138
  v_permlane32_swap_b32 v137, v139
  v_add_f32 v136, v136, v138
  v_add_f32 v137, v137, v139
  s_lshl_b32 s28, s45, 7
  s_lshl_b32 s29, s43, 14
  s_add_u32 s28, s28, s29
  s_add_u32 s28, s28, s20
  s_add_u32 s28, s28, 0x1180000
  buffer_store_dwordx2 v[136:137], v253, s[4:7], s28 offen sc1
  s_mul_i32 s27, s17, 128
  s_add_u32 s27, s27, s3
  s_add_u32 s27, s27, 0x3800
  s_add_u32 m0, s21, 0
  s_add_u32 s48, s22, 0
  buffer_load_dwordx4 v1, s[4:7], s48 offen lds
  buffer_load_dwordx4 v1, s[4:7], s48 offen offset:1024 lds
  buffer_load_dwordx4 v1, s[4:7], s48 offen offset:2048 lds
  buffer_load_dwordx4 v1, s[4:7], s48 offen offset:3072 lds
  s_add_u32 m0, s21, 4096
  s_add_u32 s48, s22, 4096
  buffer_load_dwordx4 v1, s[4:7], s48 offen lds
  s_add_u32 m0, s21, 20480
  s_add_u32 s48, s22, 20480
  buffer_load_dwordx4 v1, s[4:7], s48 offen lds
  buffer_load_dwordx4 v1, s[4:7], s48 offen offset:1024 lds
  buffer_load_dwordx4 v1, s[4:7], s48 offen offset:2048 lds
  buffer_load_dwordx4 v1, s[4:7], s48 offen offset:3072 lds
  s_add_u32 m0, s21, 24576
  s_add_u32 s48, s22, 24576
  buffer_load_dwordx4 v1, s[4:7], s48 offen lds
  s_waitcnt vmcnt(10)
  s_barrier
  s_cmp_lg_u32 s16, 0
  s_cbranch_scc1 M_sig_25
  s_mov_b64 exec, 1
  buffer_atomic_add v5, v4, s[4:7], s27 offen sc1
  s_mov_b64 exec, -1
M_sig_25:
  s_cmp_eq_u32 s16, 0
  s_cbranch_scc1 M_side_26
  s_add_u32 m0, s21, 40960
  s_add_u32 s48, s22, 40960
  buffer_load_dwordx4 v1, s[4:7], s48 offen lds
  buffer_load_dwordx4 v1, s[4:7], s48 offen offset:1024 lds
  buffer_load_dwordx4 v1, s[4:7], s48 offen offset:2048 lds
  buffer_load_dwordx4 v1, s[4:7], s48 offen offset:3072 lds
  s_add_u32 m0, s21, 45056
  s_add_u32 s48, s22, 45056
  buffer_load_dwordx4 v1, s[4:7], s48 offen lds
  s_add_u32 m0, s56, 40960
  s_add_u32 s48, s22, 40960
  s_add_u32 s48, s48, s57
  buffer_load_dwordx4 v1, s[4:7], s48 offen lds
  buffer_load_dwordx4 v1, s[4:7], s48 offen offset:1024 lds
M_side_26:
  s_branch M_d_done_24
M_d_last_23:
  s_mul_i32 s26, s45, 20480
  s_mul_i32 s27, s43, 160
  s_add_u32 s26, s26, s27
  buffer_store_dwordx4 v[240:243], v251, s[12:15], s26 offen
  buffer_store_dwordx4 v[244:247], v251, s[12:15], s26 offen offset:64
  buffer_store_dwordx2 v[248:249], v252, s[12:15], s26 offen
  s_endpgm
M_d_done_24:
  s_add_u32 s19, s19, 1
  s_add_u32 s20, s20, 0xf00000
  s_add_u32 s3, s3, 0x3800
  s_branch M_LAYER
M_END:
  s_endpgm
M_CODE_END:
.section .rodata,"a"
.p2align 6
.amdhsa_kernel prep_kernel
  .amdhsa_next_free_vgpr 128
  .amdhsa_next_free_sgpr 96
  .amdhsa_accum_offset 128
  .amdhsa_group_segment_fixed_size 0
  .amdhsa_kernarg_size 88
  .amdhsa_user_sgpr_count 2
  .amdhsa_user_sgpr_kernarg_segment_ptr 1
  .amdhsa_system_sgpr_workgroup_id_x 1
.end_amdhsa_kernel
.p2align 6
.amdhsa_kernel hedgehog_main_kernel
  .amdhsa_next_free_vgpr 512
  .amdhsa_next_free_sgpr 96
  .amdhsa_accum_offset 256
  .amdhsa_group_segment_fixed_size 0
  .amdhsa_kernarg_size 88
  .amdhsa_user_sgpr_count 2
  .amdhsa_user_sgpr_kernarg_segment_ptr 1
  .amdhsa_system_sgpr_workgroup_id_x 1
.end_amdhsa_kernel
```
